```python
import torch

def _softmax(x, axis=-1):
    return torch.softmax(x, dim=axis)
def _gelu(x):
    return torch.nn.functional.gelu(x, approximate="tanh")
def _silu(x):
    return torch.nn.functional.silu(x)
def _sigmoid(x):
    return torch.sigmoid(x)
def _layernorm(x, axis=-1, eps=1e-5):
    m = x.mean(dim=axis, keepdim=True)
    v = x.var(dim=axis, keepdim=True, unbiased=False)
    return (x - m) / torch.sqrt(v + eps)
def _scatter_add(tgt, idx, src, axis=0):
    return tgt.clone().index_add_(axis, idx, src)
def _segment_sum(src, seg, n):
    out = torch.zeros((n,) + src.shape[1:], dtype=src.dtype)
    return out.index_add_(0, seg, src)
def _pad(x, pw):
    flat = tuple(v for pair in reversed(pw) for v in pair)
    return torch.nn.functional.pad(x, flat)

kernel_name = 'standalone__mha_softmax__near_ridge'

def setup_inputs():

    _w = (lambda a: (lambda t: t.to(torch.bfloat16) if t.is_floating_point() else t)(torch.as_tensor(a)))
    B, H, Sq, Sk, D = 8, 32, 496, 512, 128
    return {
        "q": _w((lambda *s: torch.randn(*s, dtype=torch.bfloat16) * 0.8)(B, H, Sq, D)),
        "k": _w((lambda *s: torch.randn(*s, dtype=torch.bfloat16) * 0.8)(B, H, Sk, D)),
        "v": _w((lambda *s: torch.randn(*s, dtype=torch.bfloat16) * 0.05)(B, H, Sk, D)),
    }

def reference(q, k, v):
    scale = q.shape[-1] ** -0.5
    scores = torch.einsum("bhqd,bhkd->bhqk", q, k) * scale
    p = _softmax(scores, axis=-1)
    return torch.einsum("bhqk,bhkd->bhqd", p, v)
```

```asm
; @launch grid=(256,1,1) block=(512,1,1) lds=163840
.amdgcn_target "amdgcn-amd-amdhsa--gfx950"
.text
.globl standalone__mha_softmax__near_ridge_kernel
.p2align 8
.type standalone__mha_softmax__near_ridge_kernel,@function
standalone__mha_softmax__near_ridge_kernel:
    s_cmp_ge_u32 s2, 256
    s_cbranch_scc1 L_end
    s_load_dwordx4 s[40:43], s[0:1], 0
    s_load_dwordx4 s[44:47], s[0:1], 16
    s_load_dwordx2 s[4:5], s[0:1], 40
    v_and_b32 v128, 63, v0
    v_lshrrev_b32 v129, 6, v0
    s_nop 0
    v_readfirstlane_b32 s33, v129
    s_and_b32 s3, s2, 7
    s_lshr_b32 s6, s2, 4
    s_lshl_b32 s3, s3, 4
    s_add_u32 s3, s3, s6
    s_lshr_b32 s7, s2, 3
    s_and_b32 s7, s7, 1
    v_lshrrev_b32 v130, 5, v128
    v_and_b32 v131, 15, v128
    v_and_b32 v132, 31, v128
    v_lshrrev_b32 v137, 4, v128
    v_lshrrev_b32 v133, 4, v0
    v_and_b32 v134, 15, v133
    v_xor_b32 v134, v134, v131
    v_lshlrev_b32 v134, 4, v134
    v_lshl_add_u32 v220, v133, 8, v134
    v_and_b32 v134, 7, v133
    v_lshlrev_b32 v134, 1, v134
    v_xor_b32 v134, v134, v131
    v_lshlrev_b32 v134, 4, v134
    v_lshl_add_u32 v221, v133, 8, v134
    v_and_b32 v138, 1, v137
    v_lshl_add_u32 v138, v138, 1, v130
    v_lshrrev_b32 v133, 2, v0
    v_lshlrev_b32 v133, 9, v133
    v_and_b32 v134, 3, v128
    v_lshl_add_u32 v133, v134, 4, v133
    v_lshl_add_u32 v224, v131, 2, v138
    v_lshlrev_b32 v224, 2, v224
    v_and_b32 v136, 1, v128
    v_lshlrev_b32 v136, 7, v136
    v_and_b32 v134, 2, v128
    v_lshl_add_u32 v136, v134, 5, v136
    v_and_b32 v134, 60, v128
    v_add_u32 v225, v136, v134
    s_lshl_b32 s6, s7, 16
    v_add_u32 v222, s6, v133
    s_xor_b32 s6, s6, 0x10000
    v_add_u32 v223, s6, v133
    v_lshlrev_b32 v133, 4, v129
    v_add_u32 v133, v133, v131
    v_lshlrev_b32 v133, 9, v133
    v_lshl_add_u32 v133, v138, 4, v133
    v_add_u32 v239, s6, v133
    v_xor_b32 v238, 0x10000, v239
    s_waitcnt lgkmcnt(0)
    s_mul_i32 s6, s3, 0x40000
    s_add_u32 s16, s42, s6
    s_addc_u32 s17, s43, 0
    s_mov_b32 s18, 0x40000
    s_mov_b32 s19, 0x20000
    s_add_u32 s20, s44, s6
    s_addc_u32 s21, s45, 0
    s_mov_b32 s22, 0x40000
    s_mov_b32 s23, 0x20000
    s_lshl_b32 s33, s33, 10
    s_cmp_ge_u32 s33, 4096
    s_cselect_b64 vcc, -1, 0
    s_cselect_b32 s48, 16384, 0
    s_cselect_b32 s49, 81920, 0
    s_add_u32 s35, s33, s48
    s_sub_u32 s49, s35, s49
    s_add_u32 m0, s33, 0
    s_mov_b32 s34, 0
    buffer_load_dwordx4 v220, s[16:19], s34 offen nt lds
    s_add_u32 m0, s33, 8192
    s_mov_b32 s34, 8192
    buffer_load_dwordx4 v220, s[16:19], s34 offen nt lds
    s_mul_i32 s6, s3, 253952
    s_add_u32 s8, s40, s6
    s_addc_u32 s9, s41, 0
    s_mov_b32 s10, 126976
    s_mov_b32 s11, 0x20000
    s_add_u32 s12, s8, 126976
    s_addc_u32 s13, s9, 0
    s_mov_b32 s14, 126976
    s_mov_b32 s15, 0x20000
    s_add_u32 s24, s46, s6
    s_addc_u32 s25, s47, 0
    s_mov_b32 s26, 126976
    s_mov_b32 s27, 0x20000
    s_add_u32 s28, s24, 126976
    s_addc_u32 s29, s25, 0
    s_mov_b32 s30, 126976
    s_mov_b32 s31, 0x20000
    s_cbranch_vccnz L_g1
    buffer_load_dwordx4 v[64:67], v238, s[8:11], 0 offen offset:0 nt
    buffer_load_dwordx4 v[72:75], v238, s[8:11], 0 offen offset:64 nt
    buffer_load_dwordx4 v[68:71], v238, s[8:11], 0 offen offset:256 nt
    buffer_load_dwordx4 v[76:79], v238, s[8:11], 0 offen offset:320 nt
    buffer_load_dwordx4 v[80:83], v238, s[8:11], 0 offen offset:128 nt
    buffer_load_dwordx4 v[88:91], v238, s[8:11], 0 offen offset:192 nt
    buffer_load_dwordx4 v[84:87], v238, s[8:11], 0 offen offset:384 nt
    buffer_load_dwordx4 v[92:95], v238, s[8:11], 0 offen offset:448 nt
L_g1:
    s_add_u32 m0, s33, 81920
    s_mov_b32 s34, 0
    buffer_load_dwordx4 v221, s[20:23], s34 offen nt lds
    s_add_u32 m0, s33, 16384
    s_mov_b32 s34, 16384
    buffer_load_dwordx4 v220, s[16:19], s34 offen nt lds
    s_add_u32 m0, s33, 90112
    s_mov_b32 s34, 8192
    buffer_load_dwordx4 v221, s[20:23], s34 offen nt lds
    s_add_u32 m0, s33, 24576
    s_mov_b32 s34, 24576
    buffer_load_dwordx4 v220, s[16:19], s34 offen nt lds
    s_cbranch_vccz L_g2
    buffer_load_dwordx4 v[64:67], v238, s[8:11], 0 offen offset:0 nt
    buffer_load_dwordx4 v[72:75], v238, s[8:11], 0 offen offset:64 nt
    buffer_load_dwordx4 v[68:71], v238, s[8:11], 0 offen offset:256 nt
    buffer_load_dwordx4 v[76:79], v238, s[8:11], 0 offen offset:320 nt
    buffer_load_dwordx4 v[80:83], v238, s[8:11], 0 offen offset:128 nt
    buffer_load_dwordx4 v[88:91], v238, s[8:11], 0 offen offset:192 nt
    buffer_load_dwordx4 v[84:87], v238, s[8:11], 0 offen offset:384 nt
    buffer_load_dwordx4 v[92:95], v238, s[8:11], 0 offen offset:448 nt
L_g2:
    v_lshrrev_b32 v135, 2, v131
    v_add_u32 v133, 0, v138
    v_xor_b32 v133, v133, v131
    v_lshlrev_b32 v133, 4, v133
    v_lshl_add_u32 v208, v131, 8, v133
    v_add_u32 v133, 4, v138
    v_xor_b32 v133, v133, v131
    v_lshlrev_b32 v133, 4, v133
    v_lshl_add_u32 v209, v131, 8, v133
    v_add_u32 v133, 8, v138
    v_xor_b32 v133, v133, v131
    v_lshlrev_b32 v133, 4, v133
    v_lshl_add_u32 v210, v131, 8, v133
    v_add_u32 v133, 12, v138
    v_xor_b32 v133, v133, v131
    v_lshlrev_b32 v133, 4, v133
    v_lshl_add_u32 v211, v131, 8, v133
    v_lshrrev_b32 v134, 2, v128
    v_lshlrev_b32 v133, 8, v134
    v_and_b32 v136, 3, v128
    v_lshl_add_u32 v133, v136, 3, v133
    v_add_u32 v133, 81920, v133
    v_and_b32 v134, 7, v134
    v_xor_b32 v136, 0, v134
    v_lshl_add_u32 v212, v136, 5, v133
    v_xor_b32 v136, 1, v134
    v_lshl_add_u32 v213, v136, 5, v133
    v_xor_b32 v136, 2, v134
    v_lshl_add_u32 v214, v136, 5, v133
    v_xor_b32 v136, 3, v134
    v_lshl_add_u32 v215, v136, 5, v133
    v_xor_b32 v136, 4, v134
    v_lshl_add_u32 v216, v136, 5, v133
    v_xor_b32 v136, 5, v134
    v_lshl_add_u32 v217, v136, 5, v133
    v_xor_b32 v136, 6, v134
    v_lshl_add_u32 v218, v136, 5, v133
    v_xor_b32 v136, 7, v134
    v_lshl_add_u32 v219, v136, 5, v133
    s_mov_b32 s32, 0x3e0293ee
    s_mov_b32 s40, 0x3f803f80
    v_mov_b32 v248, 0x3f803f80
    v_mov_b32 v249, 0x3f803f80
    v_mov_b32 v250, 0x3f803f80
    v_mov_b32 v251, 0x3f803f80
    s_cbranch_vccnz L_g7
    s_waitcnt vmcnt(11)
    v_lshlrev_b32 v234, 16, v64
    v_and_b32 v235, 0xffff0000, v64
    v_pk_mul_f32 v[234:235], v[234:235], s[32:33] op_sel_hi:[1,0]
    v_lshlrev_b32 v236, 16, v65
    v_and_b32 v237, 0xffff0000, v65
    v_pk_mul_f32 v[236:237], v[236:237], s[32:33] op_sel_hi:[1,0]
    v_cvt_pk_bf16_f32 v64, v234, v235
    v_lshlrev_b32 v234, 16, v66
    v_and_b32 v235, 0xffff0000, v66
    v_pk_mul_f32 v[234:235], v[234:235], s[32:33] op_sel_hi:[1,0]
    v_cvt_pk_bf16_f32 v65, v236, v237
    v_lshlrev_b32 v236, 16, v67
    v_and_b32 v237, 0xffff0000, v67
    v_pk_mul_f32 v[236:237], v[236:237], s[32:33] op_sel_hi:[1,0]
    v_cvt_pk_bf16_f32 v66, v234, v235
    v_cvt_pk_bf16_f32 v67, v236, v237
    s_waitcnt vmcnt(10)
    v_lshlrev_b32 v234, 16, v72
    v_and_b32 v235, 0xffff0000, v72
    v_pk_mul_f32 v[234:235], v[234:235], s[32:33] op_sel_hi:[1,0]
    v_lshlrev_b32 v236, 16, v73
    v_and_b32 v237, 0xffff0000, v73
    v_pk_mul_f32 v[236:237], v[236:237], s[32:33] op_sel_hi:[1,0]
    v_cvt_pk_bf16_f32 v72, v234, v235
    v_lshlrev_b32 v234, 16, v74
    v_and_b32 v235, 0xffff0000, v74
    v_pk_mul_f32 v[234:235], v[234:235], s[32:33] op_sel_hi:[1,0]
    v_cvt_pk_bf16_f32 v73, v236, v237
    v_lshlrev_b32 v236, 16, v75
    v_and_b32 v237, 0xffff0000, v75
    v_pk_mul_f32 v[236:237], v[236:237], s[32:33] op_sel_hi:[1,0]
    v_cvt_pk_bf16_f32 v74, v234, v235
    v_cvt_pk_bf16_f32 v75, v236, v237
    s_waitcnt vmcnt(9)
    v_lshlrev_b32 v234, 16, v68
    v_and_b32 v235, 0xffff0000, v68
    v_pk_mul_f32 v[234:235], v[234:235], s[32:33] op_sel_hi:[1,0]
    v_lshlrev_b32 v236, 16, v69
    v_and_b32 v237, 0xffff0000, v69
    v_pk_mul_f32 v[236:237], v[236:237], s[32:33] op_sel_hi:[1,0]
    v_cvt_pk_bf16_f32 v68, v234, v235
    v_lshlrev_b32 v234, 16, v70
    v_and_b32 v235, 0xffff0000, v70
    v_pk_mul_f32 v[234:235], v[234:235], s[32:33] op_sel_hi:[1,0]
    v_cvt_pk_bf16_f32 v69, v236, v237
    v_lshlrev_b32 v236, 16, v71
    v_and_b32 v237, 0xffff0000, v71
    v_pk_mul_f32 v[236:237], v[236:237], s[32:33] op_sel_hi:[1,0]
    v_cvt_pk_bf16_f32 v70, v234, v235
    v_cvt_pk_bf16_f32 v71, v236, v237
    s_waitcnt vmcnt(8)
    v_lshlrev_b32 v234, 16, v76
    v_and_b32 v235, 0xffff0000, v76
    v_pk_mul_f32 v[234:235], v[234:235], s[32:33] op_sel_hi:[1,0]
    v_lshlrev_b32 v236, 16, v77
    v_and_b32 v237, 0xffff0000, v77
    v_pk_mul_f32 v[236:237], v[236:237], s[32:33] op_sel_hi:[1,0]
    v_cvt_pk_bf16_f32 v76, v234, v235
    v_lshlrev_b32 v234, 16, v78
    v_and_b32 v235, 0xffff0000, v78
    v_pk_mul_f32 v[234:235], v[234:235], s[32:33] op_sel_hi:[1,0]
    v_cvt_pk_bf16_f32 v77, v236, v237
    v_lshlrev_b32 v236, 16, v79
    v_and_b32 v237, 0xffff0000, v79
    v_pk_mul_f32 v[236:237], v[236:237], s[32:33] op_sel_hi:[1,0]
    v_cvt_pk_bf16_f32 v78, v234, v235
    v_cvt_pk_bf16_f32 v79, v236, v237
    s_waitcnt vmcnt(7)
    v_lshlrev_b32 v234, 16, v80
    v_and_b32 v235, 0xffff0000, v80
    v_pk_mul_f32 v[234:235], v[234:235], s[32:33] op_sel_hi:[1,0]
    v_lshlrev_b32 v236, 16, v81
    v_and_b32 v237, 0xffff0000, v81
    v_pk_mul_f32 v[236:237], v[236:237], s[32:33] op_sel_hi:[1,0]
    v_cvt_pk_bf16_f32 v80, v234, v235
    v_lshlrev_b32 v234, 16, v82
    v_and_b32 v235, 0xffff0000, v82
    v_pk_mul_f32 v[234:235], v[234:235], s[32:33] op_sel_hi:[1,0]
    v_cvt_pk_bf16_f32 v81, v236, v237
    v_lshlrev_b32 v236, 16, v83
    v_and_b32 v237, 0xffff0000, v83
    v_pk_mul_f32 v[236:237], v[236:237], s[32:33] op_sel_hi:[1,0]
    v_cvt_pk_bf16_f32 v82, v234, v235
    v_cvt_pk_bf16_f32 v83, v236, v237
    s_waitcnt vmcnt(6)
    v_lshlrev_b32 v234, 16, v88
    v_and_b32 v235, 0xffff0000, v88
    v_pk_mul_f32 v[234:235], v[234:235], s[32:33] op_sel_hi:[1,0]
    v_lshlrev_b32 v236, 16, v89
    v_and_b32 v237, 0xffff0000, v89
    v_pk_mul_f32 v[236:237], v[236:237], s[32:33] op_sel_hi:[1,0]
    v_cvt_pk_bf16_f32 v88, v234, v235
    v_lshlrev_b32 v234, 16, v90
    v_and_b32 v235, 0xffff0000, v90
    v_pk_mul_f32 v[234:235], v[234:235], s[32:33] op_sel_hi:[1,0]
    v_cvt_pk_bf16_f32 v89, v236, v237
    v_lshlrev_b32 v236, 16, v91
    v_and_b32 v237, 0xffff0000, v91
    v_pk_mul_f32 v[236:237], v[236:237], s[32:33] op_sel_hi:[1,0]
    v_cvt_pk_bf16_f32 v90, v234, v235
    v_cvt_pk_bf16_f32 v91, v236, v237
    s_waitcnt vmcnt(5)
    v_lshlrev_b32 v234, 16, v84
    v_and_b32 v235, 0xffff0000, v84
    v_pk_mul_f32 v[234:235], v[234:235], s[32:33] op_sel_hi:[1,0]
    v_lshlrev_b32 v236, 16, v85
    v_and_b32 v237, 0xffff0000, v85
    v_pk_mul_f32 v[236:237], v[236:237], s[32:33] op_sel_hi:[1,0]
    v_cvt_pk_bf16_f32 v84, v234, v235
    v_lshlrev_b32 v234, 16, v86
    v_and_b32 v235, 0xffff0000, v86
    v_pk_mul_f32 v[234:235], v[234:235], s[32:33] op_sel_hi:[1,0]
    v_cvt_pk_bf16_f32 v85, v236, v237
    v_lshlrev_b32 v236, 16, v87
    v_and_b32 v237, 0xffff0000, v87
    v_pk_mul_f32 v[236:237], v[236:237], s[32:33] op_sel_hi:[1,0]
    v_cvt_pk_bf16_f32 v86, v234, v235
    v_cvt_pk_bf16_f32 v87, v236, v237
    s_waitcnt vmcnt(4)
    v_lshlrev_b32 v234, 16, v92
    v_and_b32 v235, 0xffff0000, v92
    v_pk_mul_f32 v[234:235], v[234:235], s[32:33] op_sel_hi:[1,0]
    v_lshlrev_b32 v236, 16, v93
    v_and_b32 v237, 0xffff0000, v93
    v_pk_mul_f32 v[236:237], v[236:237], s[32:33] op_sel_hi:[1,0]
    v_cvt_pk_bf16_f32 v92, v234, v235
    v_lshlrev_b32 v234, 16, v94
    v_and_b32 v235, 0xffff0000, v94
    v_pk_mul_f32 v[234:235], v[234:235], s[32:33] op_sel_hi:[1,0]
    v_cvt_pk_bf16_f32 v93, v236, v237
    v_lshlrev_b32 v236, 16, v95
    v_and_b32 v237, 0xffff0000, v95
    v_pk_mul_f32 v[236:237], v[236:237], s[32:33] op_sel_hi:[1,0]
    v_cvt_pk_bf16_f32 v94, v234, v235
    v_cvt_pk_bf16_f32 v95, v236, v237
L_g7:
    s_waitcnt vmcnt(12)
    s_barrier
    ds_read_b128 v[176:179], v208 offset:0
    ds_read_b128 v[180:183], v209 offset:0
    ds_read_b128 v[184:187], v210 offset:0
    ds_read_b128 v[188:191], v211 offset:0
    ds_read_b128 v[192:195], v208 offset:4096
    ds_read_b128 v[196:199], v209 offset:4096
    ds_read_b128 v[200:203], v210 offset:4096
    ds_read_b128 v[204:207], v211 offset:4096
    s_cbranch_vccz L_g8
    s_add_u32 m0, s33, 98304
    s_mov_b32 s34, 16384
    buffer_load_dwordx4 v221, s[20:23], s34 offen nt lds
    s_add_u32 m0, s33, 32768
    s_mov_b32 s34, 32768
    buffer_load_dwordx4 v220, s[16:19], s34 offen nt lds
    s_add_u32 m0, s33, 106496
    s_mov_b32 s34, 24576
    buffer_load_dwordx4 v221, s[20:23], s34 offen nt lds
    s_add_u32 m0, s33, 40960
    s_mov_b32 s34, 40960
    buffer_load_dwordx4 v220, s[16:19], s34 offen nt lds
L_g8:
    s_cbranch_vccz L_g9
    s_waitcnt vmcnt(14)
    s_barrier
L_g9:
    s_cbranch_vccnz L_g10
    s_nop 0
L_g10:
    s_cbranch_vccz L_g11
    s_waitcnt vmcnt(4)
    s_nop 0
L_g11:
    s_cbranch_vccz L_g12
    v_lshlrev_b32 v234, 16, v64
    v_and_b32 v235, 0xffff0000, v64
    v_pk_mul_f32 v[234:235], v[234:235], s[32:33] op_sel_hi:[1,0]
    v_lshlrev_b32 v236, 16, v65
    v_and_b32 v237, 0xffff0000, v65
    v_pk_mul_f32 v[236:237], v[236:237], s[32:33] op_sel_hi:[1,0]
    v_cvt_pk_bf16_f32 v64, v234, v235
    v_lshlrev_b32 v234, 16, v66
    v_and_b32 v235, 0xffff0000, v66
    v_pk_mul_f32 v[234:235], v[234:235], s[32:33] op_sel_hi:[1,0]
    v_cvt_pk_bf16_f32 v65, v236, v237
    v_lshlrev_b32 v236, 16, v67
    v_and_b32 v237, 0xffff0000, v67
    v_pk_mul_f32 v[236:237], v[236:237], s[32:33] op_sel_hi:[1,0]
    v_cvt_pk_bf16_f32 v66, v234, v235
    v_cvt_pk_bf16_f32 v67, v236, v237
    v_lshlrev_b32 v234, 16, v72
    v_and_b32 v235, 0xffff0000, v72
    v_pk_mul_f32 v[234:235], v[234:235], s[32:33] op_sel_hi:[1,0]
    v_lshlrev_b32 v236, 16, v73
    v_and_b32 v237, 0xffff0000, v73
    v_pk_mul_f32 v[236:237], v[236:237], s[32:33] op_sel_hi:[1,0]
    v_cvt_pk_bf16_f32 v72, v234, v235
    v_lshlrev_b32 v234, 16, v74
    v_and_b32 v235, 0xffff0000, v74
    v_pk_mul_f32 v[234:235], v[234:235], s[32:33] op_sel_hi:[1,0]
    v_cvt_pk_bf16_f32 v73, v236, v237
    v_lshlrev_b32 v236, 16, v75
    v_and_b32 v237, 0xffff0000, v75
    v_pk_mul_f32 v[236:237], v[236:237], s[32:33] op_sel_hi:[1,0]
    v_cvt_pk_bf16_f32 v74, v234, v235
    v_cvt_pk_bf16_f32 v75, v236, v237
    v_lshlrev_b32 v234, 16, v68
    v_and_b32 v235, 0xffff0000, v68
    v_pk_mul_f32 v[234:235], v[234:235], s[32:33] op_sel_hi:[1,0]
    v_lshlrev_b32 v236, 16, v69
    v_and_b32 v237, 0xffff0000, v69
    v_pk_mul_f32 v[236:237], v[236:237], s[32:33] op_sel_hi:[1,0]
    v_cvt_pk_bf16_f32 v68, v234, v235
    v_lshlrev_b32 v234, 16, v70
    v_and_b32 v235, 0xffff0000, v70
    v_pk_mul_f32 v[234:235], v[234:235], s[32:33] op_sel_hi:[1,0]
    v_cvt_pk_bf16_f32 v69, v236, v237
    v_lshlrev_b32 v236, 16, v71
    v_and_b32 v237, 0xffff0000, v71
    v_pk_mul_f32 v[236:237], v[236:237], s[32:33] op_sel_hi:[1,0]
    v_cvt_pk_bf16_f32 v70, v234, v235
    v_cvt_pk_bf16_f32 v71, v236, v237
    v_lshlrev_b32 v234, 16, v76
    v_and_b32 v235, 0xffff0000, v76
    v_pk_mul_f32 v[234:235], v[234:235], s[32:33] op_sel_hi:[1,0]
    v_lshlrev_b32 v236, 16, v77
    v_and_b32 v237, 0xffff0000, v77
    v_pk_mul_f32 v[236:237], v[236:237], s[32:33] op_sel_hi:[1,0]
    v_cvt_pk_bf16_f32 v76, v234, v235
    v_lshlrev_b32 v234, 16, v78
    v_and_b32 v235, 0xffff0000, v78
    v_pk_mul_f32 v[234:235], v[234:235], s[32:33] op_sel_hi:[1,0]
    v_cvt_pk_bf16_f32 v77, v236, v237
    v_lshlrev_b32 v236, 16, v79
    v_and_b32 v237, 0xffff0000, v79
    v_pk_mul_f32 v[236:237], v[236:237], s[32:33] op_sel_hi:[1,0]
    v_cvt_pk_bf16_f32 v78, v234, v235
    v_cvt_pk_bf16_f32 v79, v236, v237
    v_lshlrev_b32 v234, 16, v80
    v_and_b32 v235, 0xffff0000, v80
    v_pk_mul_f32 v[234:235], v[234:235], s[32:33] op_sel_hi:[1,0]
    v_lshlrev_b32 v236, 16, v81
    v_and_b32 v237, 0xffff0000, v81
    v_pk_mul_f32 v[236:237], v[236:237], s[32:33] op_sel_hi:[1,0]
    v_cvt_pk_bf16_f32 v80, v234, v235
    v_lshlrev_b32 v234, 16, v82
    v_and_b32 v235, 0xffff0000, v82
    v_pk_mul_f32 v[234:235], v[234:235], s[32:33] op_sel_hi:[1,0]
    v_cvt_pk_bf16_f32 v81, v236, v237
    v_lshlrev_b32 v236, 16, v83
    v_and_b32 v237, 0xffff0000, v83
    v_pk_mul_f32 v[236:237], v[236:237], s[32:33] op_sel_hi:[1,0]
    v_cvt_pk_bf16_f32 v82, v234, v235
    v_cvt_pk_bf16_f32 v83, v236, v237
    v_lshlrev_b32 v234, 16, v88
    v_and_b32 v235, 0xffff0000, v88
    v_pk_mul_f32 v[234:235], v[234:235], s[32:33] op_sel_hi:[1,0]
    v_lshlrev_b32 v236, 16, v89
    v_and_b32 v237, 0xffff0000, v89
    v_pk_mul_f32 v[236:237], v[236:237], s[32:33] op_sel_hi:[1,0]
    v_cvt_pk_bf16_f32 v88, v234, v235
    v_lshlrev_b32 v234, 16, v90
    v_and_b32 v235, 0xffff0000, v90
    v_pk_mul_f32 v[234:235], v[234:235], s[32:33] op_sel_hi:[1,0]
    v_cvt_pk_bf16_f32 v89, v236, v237
    v_lshlrev_b32 v236, 16, v91
    v_and_b32 v237, 0xffff0000, v91
    v_pk_mul_f32 v[236:237], v[236:237], s[32:33] op_sel_hi:[1,0]
    v_cvt_pk_bf16_f32 v90, v234, v235
    v_cvt_pk_bf16_f32 v91, v236, v237
    v_lshlrev_b32 v234, 16, v84
    v_and_b32 v235, 0xffff0000, v84
    v_pk_mul_f32 v[234:235], v[234:235], s[32:33] op_sel_hi:[1,0]
    v_lshlrev_b32 v236, 16, v85
    v_and_b32 v237, 0xffff0000, v85
    v_pk_mul_f32 v[236:237], v[236:237], s[32:33] op_sel_hi:[1,0]
    v_cvt_pk_bf16_f32 v84, v234, v235
    v_lshlrev_b32 v234, 16, v86
    v_and_b32 v235, 0xffff0000, v86
    v_pk_mul_f32 v[234:235], v[234:235], s[32:33] op_sel_hi:[1,0]
    v_cvt_pk_bf16_f32 v85, v236, v237
    v_lshlrev_b32 v236, 16, v87
    v_and_b32 v237, 0xffff0000, v87
    v_pk_mul_f32 v[236:237], v[236:237], s[32:33] op_sel_hi:[1,0]
    v_cvt_pk_bf16_f32 v86, v234, v235
    v_cvt_pk_bf16_f32 v87, v236, v237
    v_lshlrev_b32 v234, 16, v92
    v_and_b32 v235, 0xffff0000, v92
    v_pk_mul_f32 v[234:235], v[234:235], s[32:33] op_sel_hi:[1,0]
    v_lshlrev_b32 v236, 16, v93
    v_and_b32 v237, 0xffff0000, v93
    v_pk_mul_f32 v[236:237], v[236:237], s[32:33] op_sel_hi:[1,0]
    v_cvt_pk_bf16_f32 v92, v234, v235
    v_lshlrev_b32 v234, 16, v94
    v_and_b32 v235, 0xffff0000, v94
    v_pk_mul_f32 v[234:235], v[234:235], s[32:33] op_sel_hi:[1,0]
    v_cvt_pk_bf16_f32 v93, v236, v237
    v_lshlrev_b32 v236, 16, v95
    v_and_b32 v237, 0xffff0000, v95
    v_pk_mul_f32 v[236:237], v[236:237], s[32:33] op_sel_hi:[1,0]
    v_cvt_pk_bf16_f32 v94, v234, v235
    v_cvt_pk_bf16_f32 v95, v236, v237
L_g12:
    s_cbranch_vccz L_g13
    s_barrier
L_g13:
    s_waitcnt lgkmcnt(0)
    s_setprio 0
    v_mfma_f32_16x16x32_bf16 v[128:131], v[176:179], v[64:67], 0
    v_mfma_f32_16x16x32_bf16 v[136:139], v[176:179], v[68:71], 0
    v_mfma_f32_16x16x32_bf16 v[128:131], v[180:183], v[72:75], v[128:131]
    v_mfma_f32_16x16x32_bf16 v[136:139], v[180:183], v[76:79], v[136:139]
    v_mfma_f32_16x16x32_bf16 v[128:131], v[184:187], v[80:83], v[128:131]
    v_mfma_f32_16x16x32_bf16 v[136:139], v[184:187], v[84:87], v[136:139]
    v_mfma_f32_16x16x32_bf16 v[128:131], v[188:191], v[88:91], v[128:131]
    v_mfma_f32_16x16x32_bf16 v[136:139], v[188:191], v[92:95], v[136:139]
    v_mfma_f32_16x16x32_bf16 v[132:135], v[192:195], v[64:67], 0
    s_setprio 1
    v_mfma_f32_16x16x32_bf16 v[140:143], v[192:195], v[68:71], 0
    v_mfma_f32_16x16x32_bf16 v[132:135], v[196:199], v[72:75], v[132:135]
    v_mfma_f32_16x16x32_bf16 v[140:143], v[196:199], v[76:79], v[140:143]
    v_mfma_f32_16x16x32_bf16 v[132:135], v[200:203], v[80:83], v[132:135]
    v_mfma_f32_16x16x32_bf16 v[140:143], v[200:203], v[84:87], v[140:143]
    v_mfma_f32_16x16x32_bf16 v[132:135], v[204:207], v[88:91], v[132:135]
    v_mfma_f32_16x16x32_bf16 v[140:143], v[204:207], v[92:95], v[140:143]
    s_setprio 3
    s_cbranch_vccz L_g14
    s_waitcnt vmcnt(2)
    s_barrier
L_g14:
    v_max3_f32 v160, v128, v129, v130
    v_max3_f32 v161, v136, v137, v138
    s_nop 2
    v_max3_f32 v160, v160, v131, v132
    v_max3_f32 v161, v161, v139, v140
    v_max3_f32 v160, v160, v133, v134
    v_max3_f32 v161, v161, v141, v142
    v_max_f32 v160, v160, v135
    v_max_f32 v161, v161, v143
    v_mov_b32 v162, v160
    v_mov_b32 v163, v161
    s_nop 0
    v_permlane16_swap_b32 v160, v162
    v_permlane16_swap_b32 v161, v163
    v_max_f32 v160, v160, v162
    v_max_f32 v161, v161, v163
    v_mov_b32 v162, v160
    v_mov_b32 v163, v161
    s_nop 0
    v_permlane32_swap_b32 v160, v162
    v_permlane32_swap_b32 v161, v163
    v_max_f32 v160, v160, v162
    v_max_f32 v161, v161, v163
    v_sub_f32 v240, 0, v160
    v_sub_f32 v244, 0, v161
    v_sub_f32 v241, 0, v160
    v_sub_f32 v245, 0, v161
    v_sub_f32 v242, 0, v160
    v_sub_f32 v246, 0, v161
    v_sub_f32 v243, 0, v160
    v_sub_f32 v247, 0, v161
    v_add_f32 v128, v128, v240
    v_add_f32 v129, v129, v240
    v_exp_f32 v128, v128
    v_add_f32 v130, v130, v240
    v_add_f32 v131, v131, v240
    s_add_u32 m0, s35, 98304
    s_add_u32 s34, s48, 16384
    buffer_load_dwordx4 v221, s[20:23], s34 offen nt lds
    v_exp_f32 v129, v129
    v_exp_f32 v130, v130
    ds_read_b128 v[176:179], v208 offset:8192
    v_add_f32 v132, v132, v240
    v_add_f32 v133, v133, v240
    v_exp_f32 v131, v131
    s_add_u32 m0, s35, 32768
    s_add_u32 s34, s48, 32768
    buffer_load_dwordx4 v220, s[16:19], s34 offen nt lds
    v_exp_f32 v132, v132
    v_add_f32 v134, v134, v240
    v_add_f32 v135, v135, v240
    v_exp_f32 v133, v133
    ds_read_b128 v[180:183], v209 offset:8192
    v_cvt_pk_bf16_f32 v160, v128, v129
    v_cvt_pk_bf16_f32 v161, v130, v131
    v_exp_f32 v134, v134
    s_add_u32 m0, s35, 106496
    s_add_u32 s34, s48, 24576
    buffer_load_dwordx4 v221, s[20:23], s34 offen nt lds
    v_add_f32 v136, v136, v244
    v_add_f32 v137, v137, v244
    v_exp_f32 v135, v135
    ds_read_b128 v[184:187], v210 offset:8192
    v_exp_f32 v136, v136
    v_add_f32 v138, v138, v244
    v_add_f32 v139, v139, v244
    ds_read_b128 v[188:191], v211 offset:8192
    v_exp_f32 v137, v137
    v_cvt_pk_bf16_f32 v162, v132, v133
    v_cvt_pk_bf16_f32 v163, v134, v135
    v_exp_f32 v138, v138
    ds_read_b128 v[192:195], v208 offset:12288
    v_add_f32 v140, v140, v244
    v_add_f32 v141, v141, v244
    v_exp_f32 v139, v139
    ds_read_b128 v[196:199], v209 offset:12288
    v_exp_f32 v140, v140
    v_add_f32 v142, v142, v244
    v_add_f32 v143, v143, v244
    ds_read_b128 v[200:203], v210 offset:12288
    v_exp_f32 v141, v141
    v_cvt_pk_bf16_f32 v164, v136, v137
    v_cvt_pk_bf16_f32 v165, v138, v139
    ds_read_b128 v[204:207], v211 offset:12288
    v_exp_f32 v142, v142
    v_exp_f32 v143, v143
    v_cvt_pk_bf16_f32 v166, v140, v141
    v_cvt_pk_bf16_f32 v167, v142, v143
    s_cbranch_vccnz L_g15
    s_waitcnt vmcnt(5)
    s_barrier
L_g15:
    s_waitcnt lgkmcnt(0)
    s_setprio 0
    v_mfma_f32_16x16x32_bf16 v[128:131], v[176:179], v[64:67], v[240:243]
    ds_read_b64_tr_b16 v[144:145], v212 offset:0
    v_mfma_f32_16x16x32_bf16 v[136:139], v[176:179], v[68:71], v[244:247]
    ds_read_b64_tr_b16 v[146:147], v212 offset:4096
    v_mfma_f32_16x16x32_bf16 v[128:131], v[180:183], v[72:75], v[128:131]
    ds_read_b64_tr_b16 v[148:149], v213 offset:0
    v_mfma_f32_16x16x32_bf16 v[136:139], v[180:183], v[76:79], v[136:139]
    ds_read_b64_tr_b16 v[150:151], v213 offset:4096
    v_mfma_f32_16x16x32_bf16 v[128:131], v[184:187], v[80:83], v[128:131]
    ds_read_b64_tr_b16 v[152:153], v214 offset:0
    v_mfma_f32_16x16x32_bf16 v[136:139], v[184:187], v[84:87], v[136:139]
    ds_read_b64_tr_b16 v[154:155], v214 offset:4096
    v_mfma_f32_16x16x32_bf16 v[128:131], v[188:191], v[88:91], v[128:131]
    ds_read_b64_tr_b16 v[156:157], v215 offset:0
    v_mfma_f32_16x16x32_bf16 v[136:139], v[188:191], v[92:95], v[136:139]
    ds_read_b64_tr_b16 v[158:159], v215 offset:4096
    v_mfma_f32_16x16x32_bf16 v[132:135], v[192:195], v[64:67], v[240:243]
    s_setprio 1
    ds_read_b64_tr_b16 v[168:169], v216 offset:0
    v_mfma_f32_16x16x32_bf16 v[140:143], v[192:195], v[68:71], v[244:247]
    ds_read_b64_tr_b16 v[170:171], v216 offset:4096
    v_mfma_f32_16x16x32_bf16 v[132:135], v[196:199], v[72:75], v[132:135]
    ds_read_b64_tr_b16 v[172:173], v217 offset:0
    v_mfma_f32_16x16x32_bf16 v[140:143], v[196:199], v[76:79], v[140:143]
    ds_read_b64_tr_b16 v[174:175], v217 offset:4096
    v_mfma_f32_16x16x32_bf16 v[132:135], v[200:203], v[80:83], v[132:135]
    ds_read_b64_tr_b16 v[176:177], v218 offset:0
    v_mfma_f32_16x16x32_bf16 v[140:143], v[200:203], v[84:87], v[140:143]
    ds_read_b64_tr_b16 v[178:179], v218 offset:4096
    v_mfma_f32_16x16x32_bf16 v[132:135], v[204:207], v[88:91], v[132:135]
    ds_read_b64_tr_b16 v[180:181], v219 offset:0
    v_mfma_f32_16x16x32_bf16 v[140:143], v[204:207], v[92:95], v[140:143]
    ds_read_b64_tr_b16 v[182:183], v219 offset:4096
    v_mfma_f32_16x16x32_bf16 v[226:229], v[248:251], v[160:163], 0
    v_mfma_f32_16x16x32_bf16 v[252:255], v[248:251], v[164:167], 0
    s_waitcnt lgkmcnt(14)
    v_mfma_f32_16x16x32_bf16 v[0:3], v[144:147], v[160:163], 0
    v_mfma_f32_16x16x32_bf16 v[4:7], v[144:147], v[164:167], 0
    s_waitcnt lgkmcnt(12)
    v_mfma_f32_16x16x32_bf16 v[8:11], v[148:151], v[160:163], 0
    v_mfma_f32_16x16x32_bf16 v[12:15], v[148:151], v[164:167], 0
    s_waitcnt lgkmcnt(10)
    v_mfma_f32_16x16x32_bf16 v[16:19], v[152:155], v[160:163], 0
    v_mfma_f32_16x16x32_bf16 v[20:23], v[152:155], v[164:167], 0
    s_waitcnt lgkmcnt(8)
    v_mfma_f32_16x16x32_bf16 v[24:27], v[156:159], v[160:163], 0
    v_mfma_f32_16x16x32_bf16 v[28:31], v[156:159], v[164:167], 0
    s_waitcnt lgkmcnt(6)
    v_mfma_f32_16x16x32_bf16 v[32:35], v[168:171], v[160:163], 0
    v_mfma_f32_16x16x32_bf16 v[36:39], v[168:171], v[164:167], 0
    s_waitcnt lgkmcnt(4)
    v_mfma_f32_16x16x32_bf16 v[40:43], v[172:175], v[160:163], 0
    v_mfma_f32_16x16x32_bf16 v[44:47], v[172:175], v[164:167], 0
    s_waitcnt lgkmcnt(2)
    v_mfma_f32_16x16x32_bf16 v[48:51], v[176:179], v[160:163], 0
    v_mfma_f32_16x16x32_bf16 v[52:55], v[176:179], v[164:167], 0
    s_waitcnt lgkmcnt(0)
    v_mfma_f32_16x16x32_bf16 v[56:59], v[180:183], v[160:163], 0
    v_mfma_f32_16x16x32_bf16 v[60:63], v[180:183], v[164:167], 0
    s_setprio 3
    s_cbranch_vccz L_g16
    s_waitcnt vmcnt(3)
    s_barrier
L_g16:
    v_exp_f32 v128, v128
    v_exp_f32 v129, v129
    s_add_u32 m0, s35, 40960
    s_add_u32 s34, s48, 40960
    buffer_load_dwordx4 v220, s[16:19], s34 offen nt lds
    v_exp_f32 v130, v130
    v_exp_f32 v131, v131
    ds_read_b128 v[176:179], v208 offset:16384
    v_exp_f32 v132, v132
    s_add_u32 m0, s35, 114688
    s_add_u32 s34, s48, 32768
    buffer_load_dwordx4 v221, s[20:23], s34 offen nt lds
    v_exp_f32 v133, v133
    v_cvt_pk_bf16_f32 v160, v128, v129
    v_cvt_pk_bf16_f32 v161, v130, v131
    ds_read_b128 v[180:183], v209 offset:16384
    v_exp_f32 v134, v134
    s_add_u32 m0, s35, 49152
    s_add_u32 s34, s48, 49152
    buffer_load_dwordx4 v220, s[16:19], s34 offen nt lds
    v_exp_f32 v135, v135
    v_exp_f32 v136, v136
    ds_read_b128 v[184:187], v210 offset:16384
    v_exp_f32 v137, v137
    ds_read_b128 v[188:191], v211 offset:16384
    v_cvt_pk_bf16_f32 v162, v132, v133
    v_cvt_pk_bf16_f32 v163, v134, v135
    v_exp_f32 v138, v138
    ds_read_b128 v[192:195], v208 offset:20480
    v_exp_f32 v139, v139
    ds_read_b128 v[196:199], v209 offset:20480
    v_exp_f32 v140, v140
    v_exp_f32 v141, v141
    ds_read_b128 v[200:203], v210 offset:20480
    v_cvt_pk_bf16_f32 v164, v136, v137
    v_cvt_pk_bf16_f32 v165, v138, v139
    ds_read_b128 v[204:207], v211 offset:20480
    v_exp_f32 v142, v142
    v_exp_f32 v143, v143
    v_cvt_pk_bf16_f32 v166, v140, v141
    v_cvt_pk_bf16_f32 v167, v142, v143
    s_cbranch_vccnz L_g17
    s_waitcnt vmcnt(6)
    s_barrier
L_g17:
    s_waitcnt lgkmcnt(0)
    s_setprio 0
    v_mfma_f32_16x16x32_bf16 v[128:131], v[176:179], v[64:67], v[240:243]
    ds_read_b64_tr_b16 v[144:145], v212 offset:8192
    v_mfma_f32_16x16x32_bf16 v[136:139], v[176:179], v[68:71], v[244:247]
    ds_read_b64_tr_b16 v[146:147], v212 offset:12288
    v_mfma_f32_16x16x32_bf16 v[128:131], v[180:183], v[72:75], v[128:131]
    ds_read_b64_tr_b16 v[148:149], v213 offset:8192
    v_mfma_f32_16x16x32_bf16 v[136:139], v[180:183], v[76:79], v[136:139]
    ds_read_b64_tr_b16 v[150:151], v213 offset:12288
    v_mfma_f32_16x16x32_bf16 v[128:131], v[184:187], v[80:83], v[128:131]
    ds_read_b64_tr_b16 v[152:153], v214 offset:8192
    v_mfma_f32_16x16x32_bf16 v[136:139], v[184:187], v[84:87], v[136:139]
    ds_read_b64_tr_b16 v[154:155], v214 offset:12288
    v_mfma_f32_16x16x32_bf16 v[128:131], v[188:191], v[88:91], v[128:131]
    ds_read_b64_tr_b16 v[156:157], v215 offset:8192
    v_mfma_f32_16x16x32_bf16 v[136:139], v[188:191], v[92:95], v[136:139]
    ds_read_b64_tr_b16 v[158:159], v215 offset:12288
    v_mfma_f32_16x16x32_bf16 v[132:135], v[192:195], v[64:67], v[240:243]
    s_setprio 1
    ds_read_b64_tr_b16 v[168:169], v216 offset:8192
    v_mfma_f32_16x16x32_bf16 v[140:143], v[192:195], v[68:71], v[244:247]
    ds_read_b64_tr_b16 v[170:171], v216 offset:12288
    v_mfma_f32_16x16x32_bf16 v[132:135], v[196:199], v[72:75], v[132:135]
    ds_read_b64_tr_b16 v[172:173], v217 offset:8192
    v_mfma_f32_16x16x32_bf16 v[140:143], v[196:199], v[76:79], v[140:143]
    ds_read_b64_tr_b16 v[174:175], v217 offset:12288
    v_mfma_f32_16x16x32_bf16 v[132:135], v[200:203], v[80:83], v[132:135]
    ds_read_b64_tr_b16 v[176:177], v218 offset:8192
    v_mfma_f32_16x16x32_bf16 v[140:143], v[200:203], v[84:87], v[140:143]
    ds_read_b64_tr_b16 v[178:179], v218 offset:12288
    v_mfma_f32_16x16x32_bf16 v[132:135], v[204:207], v[88:91], v[132:135]
    ds_read_b64_tr_b16 v[180:181], v219 offset:8192
    v_mfma_f32_16x16x32_bf16 v[140:143], v[204:207], v[92:95], v[140:143]
    ds_read_b64_tr_b16 v[182:183], v219 offset:12288
    v_mfma_f32_16x16x32_bf16 v[226:229], v[248:251], v[160:163], v[226:229]
    v_mfma_f32_16x16x32_bf16 v[252:255], v[248:251], v[164:167], v[252:255]
    s_waitcnt lgkmcnt(14)
    v_mfma_f32_16x16x32_bf16 v[0:3], v[144:147], v[160:163], v[0:3]
    v_mfma_f32_16x16x32_bf16 v[4:7], v[144:147], v[164:167], v[4:7]
    s_waitcnt lgkmcnt(12)
    v_mfma_f32_16x16x32_bf16 v[8:11], v[148:151], v[160:163], v[8:11]
    v_mfma_f32_16x16x32_bf16 v[12:15], v[148:151], v[164:167], v[12:15]
    ds_read_b128 v[184:187], v210 offset:24576
    s_waitcnt lgkmcnt(11)
    v_mfma_f32_16x16x32_bf16 v[16:19], v[152:155], v[160:163], v[16:19]
    v_mfma_f32_16x16x32_bf16 v[20:23], v[152:155], v[164:167], v[20:23]
    ds_read_b128 v[188:191], v211 offset:24576
    s_waitcnt lgkmcnt(10)
    v_mfma_f32_16x16x32_bf16 v[24:27], v[156:159], v[160:163], v[24:27]
    v_mfma_f32_16x16x32_bf16 v[28:31], v[156:159], v[164:167], v[28:31]
    ds_read_b128 v[192:195], v208 offset:28672
    s_waitcnt lgkmcnt(9)
    v_mfma_f32_16x16x32_bf16 v[32:35], v[168:171], v[160:163], v[32:35]
    v_mfma_f32_16x16x32_bf16 v[36:39], v[168:171], v[164:167], v[36:39]
    ds_read_b128 v[196:199], v209 offset:28672
    s_waitcnt lgkmcnt(8)
    v_mfma_f32_16x16x32_bf16 v[40:43], v[172:175], v[160:163], v[40:43]
    v_mfma_f32_16x16x32_bf16 v[44:47], v[172:175], v[164:167], v[44:47]
    ds_read_b128 v[200:203], v210 offset:28672
    s_waitcnt lgkmcnt(7)
    v_mfma_f32_16x16x32_bf16 v[48:51], v[176:179], v[160:163], v[48:51]
    v_mfma_f32_16x16x32_bf16 v[52:55], v[176:179], v[164:167], v[52:55]
    ds_read_b128 v[204:207], v211 offset:28672
    s_waitcnt lgkmcnt(6)
    v_mfma_f32_16x16x32_bf16 v[56:59], v[180:183], v[160:163], v[56:59]
    v_mfma_f32_16x16x32_bf16 v[60:63], v[180:183], v[164:167], v[60:63]
    s_setprio 3
    s_cbranch_vccz L_g18
    s_waitcnt vmcnt(4)
    s_barrier
L_g18:
    v_exp_f32 v128, v128
    v_exp_f32 v129, v129
    v_exp_f32 v130, v130
    v_exp_f32 v131, v131
    s_add_u32 m0, s35, 122880
    s_add_u32 s34, s48, 40960
    buffer_load_dwordx4 v221, s[20:23], s34 offen nt lds
    v_exp_f32 v132, v132
    v_exp_f32 v133, v133
    v_cvt_pk_bf16_f32 v160, v128, v129
    v_cvt_pk_bf16_f32 v161, v130, v131
    ds_read_b128 v[176:179], v208 offset:24576
    v_exp_f32 v134, v134
    v_exp_f32 v135, v135
    v_exp_f32 v136, v136
    v_exp_f32 v137, v137
    s_add_u32 m0, s35, 57344
    s_add_u32 s34, s48, 57344
    buffer_load_dwordx4 v220, s[16:19], s34 offen nt lds
    v_cvt_pk_bf16_f32 v162, v132, v133
    v_cvt_pk_bf16_f32 v163, v134, v135
    v_exp_f32 v138, v138
    v_exp_f32 v139, v139
    ds_read_b128 v[180:183], v209 offset:24576
    v_exp_f32 v140, v140
    v_exp_f32 v141, v141
    v_cvt_pk_bf16_f32 v164, v136, v137
    v_cvt_pk_bf16_f32 v165, v138, v139
    s_add_u32 m0, s35, 131072
    s_add_u32 s34, s48, 49152
    buffer_load_dwordx4 v221, s[20:23], s34 offen nt lds
    v_exp_f32 v142, v142
    v_exp_f32 v143, v143
    v_cvt_pk_bf16_f32 v166, v140, v141
    v_cvt_pk_bf16_f32 v167, v142, v143
    s_cbranch_vccnz L_g19
    s_waitcnt vmcnt(7)
    s_barrier
L_g19:
    s_waitcnt lgkmcnt(0)
    s_setprio 0
    v_mfma_f32_16x16x32_bf16 v[128:131], v[176:179], v[64:67], v[240:243]
    ds_read_b64_tr_b16 v[144:145], v212 offset:16384
    v_mfma_f32_16x16x32_bf16 v[136:139], v[176:179], v[68:71], v[244:247]
    ds_read_b64_tr_b16 v[146:147], v212 offset:20480
    v_mfma_f32_16x16x32_bf16 v[128:131], v[180:183], v[72:75], v[128:131]
    ds_read_b64_tr_b16 v[148:149], v213 offset:16384
    v_mfma_f32_16x16x32_bf16 v[136:139], v[180:183], v[76:79], v[136:139]
    ds_read_b64_tr_b16 v[150:151], v213 offset:20480
    v_mfma_f32_16x16x32_bf16 v[128:131], v[184:187], v[80:83], v[128:131]
    ds_read_b64_tr_b16 v[152:153], v214 offset:16384
    v_mfma_f32_16x16x32_bf16 v[136:139], v[184:187], v[84:87], v[136:139]
    ds_read_b64_tr_b16 v[154:155], v214 offset:20480
    v_mfma_f32_16x16x32_bf16 v[128:131], v[188:191], v[88:91], v[128:131]
    ds_read_b64_tr_b16 v[156:157], v215 offset:16384
    v_mfma_f32_16x16x32_bf16 v[136:139], v[188:191], v[92:95], v[136:139]
    ds_read_b64_tr_b16 v[158:159], v215 offset:20480
    v_mfma_f32_16x16x32_bf16 v[132:135], v[192:195], v[64:67], v[240:243]
    s_setprio 1
    ds_read_b64_tr_b16 v[168:169], v216 offset:16384
    v_mfma_f32_16x16x32_bf16 v[140:143], v[192:195], v[68:71], v[244:247]
    ds_read_b64_tr_b16 v[170:171], v216 offset:20480
    v_mfma_f32_16x16x32_bf16 v[132:135], v[196:199], v[72:75], v[132:135]
    ds_read_b64_tr_b16 v[172:173], v217 offset:16384
    v_mfma_f32_16x16x32_bf16 v[140:143], v[196:199], v[76:79], v[140:143]
    ds_read_b64_tr_b16 v[174:175], v217 offset:20480
    v_mfma_f32_16x16x32_bf16 v[132:135], v[200:203], v[80:83], v[132:135]
    ds_read_b64_tr_b16 v[176:177], v218 offset:16384
    v_mfma_f32_16x16x32_bf16 v[140:143], v[200:203], v[84:87], v[140:143]
    ds_read_b64_tr_b16 v[178:179], v218 offset:20480
    v_mfma_f32_16x16x32_bf16 v[132:135], v[204:207], v[88:91], v[132:135]
    ds_read_b64_tr_b16 v[180:181], v219 offset:16384
    v_mfma_f32_16x16x32_bf16 v[140:143], v[204:207], v[92:95], v[140:143]
    ds_read_b64_tr_b16 v[182:183], v219 offset:20480
    v_mfma_f32_16x16x32_bf16 v[226:229], v[248:251], v[160:163], v[226:229]
    v_mfma_f32_16x16x32_bf16 v[252:255], v[248:251], v[164:167], v[252:255]
    s_waitcnt lgkmcnt(14)
    v_mfma_f32_16x16x32_bf16 v[0:3], v[144:147], v[160:163], v[0:3]
    v_mfma_f32_16x16x32_bf16 v[4:7], v[144:147], v[164:167], v[4:7]
    s_waitcnt lgkmcnt(12)
    v_mfma_f32_16x16x32_bf16 v[8:11], v[148:151], v[160:163], v[8:11]
    v_mfma_f32_16x16x32_bf16 v[12:15], v[148:151], v[164:167], v[12:15]
    ds_read_b128 v[184:187], v210 offset:32768
    s_waitcnt lgkmcnt(11)
    v_mfma_f32_16x16x32_bf16 v[16:19], v[152:155], v[160:163], v[16:19]
    v_mfma_f32_16x16x32_bf16 v[20:23], v[152:155], v[164:167], v[20:23]
    ds_read_b128 v[188:191], v211 offset:32768
    s_waitcnt lgkmcnt(10)
    v_mfma_f32_16x16x32_bf16 v[24:27], v[156:159], v[160:163], v[24:27]
    v_mfma_f32_16x16x32_bf16 v[28:31], v[156:159], v[164:167], v[28:31]
    ds_read_b128 v[192:195], v208 offset:36864
    s_waitcnt lgkmcnt(9)
    v_mfma_f32_16x16x32_bf16 v[32:35], v[168:171], v[160:163], v[32:35]
    v_mfma_f32_16x16x32_bf16 v[36:39], v[168:171], v[164:167], v[36:39]
    ds_read_b128 v[196:199], v209 offset:36864
    s_waitcnt lgkmcnt(8)
    v_mfma_f32_16x16x32_bf16 v[40:43], v[172:175], v[160:163], v[40:43]
    v_mfma_f32_16x16x32_bf16 v[44:47], v[172:175], v[164:167], v[44:47]
    ds_read_b128 v[200:203], v210 offset:36864
    s_waitcnt lgkmcnt(7)
    v_mfma_f32_16x16x32_bf16 v[48:51], v[176:179], v[160:163], v[48:51]
    v_mfma_f32_16x16x32_bf16 v[52:55], v[176:179], v[164:167], v[52:55]
    ds_read_b128 v[204:207], v211 offset:36864
    s_waitcnt lgkmcnt(6)
    v_mfma_f32_16x16x32_bf16 v[56:59], v[180:183], v[160:163], v[56:59]
    v_mfma_f32_16x16x32_bf16 v[60:63], v[180:183], v[164:167], v[60:63]
    s_setprio 3
    s_cbranch_vccz L_g20
    s_waitcnt vmcnt(3)
    s_barrier
L_g20:
    v_exp_f32 v128, v128
    v_exp_f32 v129, v129
    v_exp_f32 v130, v130
    v_exp_f32 v131, v131
    s_add_u32 m0, s49, 65536
    s_add_u32 s34, s48, 65536
    buffer_load_dwordx4 v220, s[16:19], s34 offen nt lds
    v_exp_f32 v132, v132
    v_exp_f32 v133, v133
    v_cvt_pk_bf16_f32 v160, v128, v129
    v_cvt_pk_bf16_f32 v161, v130, v131
    ds_read_b128 v[176:179], v208 offset:32768
    v_exp_f32 v134, v134
    v_exp_f32 v135, v135
    v_exp_f32 v136, v136
    v_exp_f32 v137, v137
    s_add_u32 m0, s35, 139264
    s_add_u32 s34, s48, 57344
    buffer_load_dwordx4 v221, s[20:23], s34 offen nt lds
    v_cvt_pk_bf16_f32 v162, v132, v133
    v_cvt_pk_bf16_f32 v163, v134, v135
    v_exp_f32 v138, v138
    v_exp_f32 v139, v139
    ds_read_b128 v[180:183], v209 offset:32768
    v_exp_f32 v140, v140
    v_exp_f32 v141, v141
    v_cvt_pk_bf16_f32 v164, v136, v137
    v_cvt_pk_bf16_f32 v165, v138, v139
    s_add_u32 m0, s49, 73728
    s_add_u32 s34, s48, 73728
    buffer_load_dwordx4 v220, s[16:19], s34 offen nt lds
    v_exp_f32 v142, v142
    v_exp_f32 v143, v143
    v_cvt_pk_bf16_f32 v166, v140, v141
    v_cvt_pk_bf16_f32 v167, v142, v143
    v_add_u32 v208, 40960, v208
    v_add_u32 v209, 40960, v209
    v_add_u32 v210, 40960, v210
    v_add_u32 v211, 40960, v211
    s_cbranch_vccnz L_g21
    s_waitcnt vmcnt(8)
    s_barrier
L_g21:
    s_waitcnt lgkmcnt(0)
    s_setprio 0
    v_mfma_f32_16x16x32_bf16 v[128:131], v[176:179], v[64:67], v[240:243]
    ds_read_b64_tr_b16 v[144:145], v212 offset:24576
    v_mfma_f32_16x16x32_bf16 v[136:139], v[176:179], v[68:71], v[244:247]
    ds_read_b64_tr_b16 v[146:147], v212 offset:28672
    v_mfma_f32_16x16x32_bf16 v[128:131], v[180:183], v[72:75], v[128:131]
    ds_read_b64_tr_b16 v[148:149], v213 offset:24576
    v_mfma_f32_16x16x32_bf16 v[136:139], v[180:183], v[76:79], v[136:139]
    ds_read_b64_tr_b16 v[150:151], v213 offset:28672
    v_mfma_f32_16x16x32_bf16 v[128:131], v[184:187], v[80:83], v[128:131]
    ds_read_b64_tr_b16 v[152:153], v214 offset:24576
    v_mfma_f32_16x16x32_bf16 v[136:139], v[184:187], v[84:87], v[136:139]
    ds_read_b64_tr_b16 v[154:155], v214 offset:28672
    v_mfma_f32_16x16x32_bf16 v[128:131], v[188:191], v[88:91], v[128:131]
    ds_read_b64_tr_b16 v[156:157], v215 offset:24576
    v_mfma_f32_16x16x32_bf16 v[136:139], v[188:191], v[92:95], v[136:139]
    ds_read_b64_tr_b16 v[158:159], v215 offset:28672
    v_mfma_f32_16x16x32_bf16 v[132:135], v[192:195], v[64:67], v[240:243]
    s_setprio 1
    ds_read_b64_tr_b16 v[168:169], v216 offset:24576
    v_mfma_f32_16x16x32_bf16 v[140:143], v[192:195], v[68:71], v[244:247]
    ds_read_b64_tr_b16 v[170:171], v216 offset:28672
    v_mfma_f32_16x16x32_bf16 v[132:135], v[196:199], v[72:75], v[132:135]
    ds_read_b64_tr_b16 v[172:173], v217 offset:24576
    v_mfma_f32_16x16x32_bf16 v[140:143], v[196:199], v[76:79], v[140:143]
    ds_read_b64_tr_b16 v[174:175], v217 offset:28672
    v_mfma_f32_16x16x32_bf16 v[132:135], v[200:203], v[80:83], v[132:135]
    ds_read_b64_tr_b16 v[176:177], v218 offset:24576
    v_mfma_f32_16x16x32_bf16 v[140:143], v[200:203], v[84:87], v[140:143]
    ds_read_b64_tr_b16 v[178:179], v218 offset:28672
    v_mfma_f32_16x16x32_bf16 v[132:135], v[204:207], v[88:91], v[132:135]
    ds_read_b64_tr_b16 v[180:181], v219 offset:24576
    v_mfma_f32_16x16x32_bf16 v[140:143], v[204:207], v[92:95], v[140:143]
    ds_read_b64_tr_b16 v[182:183], v219 offset:28672
    v_mfma_f32_16x16x32_bf16 v[226:229], v[248:251], v[160:163], v[226:229]
    v_mfma_f32_16x16x32_bf16 v[252:255], v[248:251], v[164:167], v[252:255]
    s_waitcnt lgkmcnt(14)
    v_mfma_f32_16x16x32_bf16 v[0:3], v[144:147], v[160:163], v[0:3]
    v_mfma_f32_16x16x32_bf16 v[4:7], v[144:147], v[164:167], v[4:7]
    s_waitcnt lgkmcnt(12)
    v_mfma_f32_16x16x32_bf16 v[8:11], v[148:151], v[160:163], v[8:11]
    v_mfma_f32_16x16x32_bf16 v[12:15], v[148:151], v[164:167], v[12:15]
    ds_read_b128 v[184:187], v210 offset:0
    s_waitcnt lgkmcnt(11)
    v_mfma_f32_16x16x32_bf16 v[16:19], v[152:155], v[160:163], v[16:19]
    v_mfma_f32_16x16x32_bf16 v[20:23], v[152:155], v[164:167], v[20:23]
    ds_read_b128 v[188:191], v211 offset:0
    s_waitcnt lgkmcnt(10)
    v_mfma_f32_16x16x32_bf16 v[24:27], v[156:159], v[160:163], v[24:27]
    v_mfma_f32_16x16x32_bf16 v[28:31], v[156:159], v[164:167], v[28:31]
    ds_read_b128 v[192:195], v208 offset:4096
    s_waitcnt lgkmcnt(9)
    v_mfma_f32_16x16x32_bf16 v[32:35], v[168:171], v[160:163], v[32:35]
    v_mfma_f32_16x16x32_bf16 v[36:39], v[168:171], v[164:167], v[36:39]
    ds_read_b128 v[196:199], v209 offset:4096
    s_waitcnt lgkmcnt(8)
    v_mfma_f32_16x16x32_bf16 v[40:43], v[172:175], v[160:163], v[40:43]
    v_mfma_f32_16x16x32_bf16 v[44:47], v[172:175], v[164:167], v[44:47]
    ds_read_b128 v[200:203], v210 offset:4096
    s_waitcnt lgkmcnt(7)
    v_mfma_f32_16x16x32_bf16 v[48:51], v[176:179], v[160:163], v[48:51]
    v_mfma_f32_16x16x32_bf16 v[52:55], v[176:179], v[164:167], v[52:55]
    ds_read_b128 v[204:207], v211 offset:4096
    s_waitcnt lgkmcnt(6)
    v_mfma_f32_16x16x32_bf16 v[56:59], v[180:183], v[160:163], v[56:59]
    v_mfma_f32_16x16x32_bf16 v[60:63], v[180:183], v[164:167], v[60:63]
    s_setprio 3
    v_exp_f32 v128, v128
    v_exp_f32 v129, v129
    v_exp_f32 v130, v130
    v_exp_f32 v131, v131
    v_exp_f32 v132, v132
    s_add_u32 m0, s49, 147456
    s_add_u32 s34, s48, 65536
    buffer_load_dwordx4 v221, s[20:23], s34 offen nt lds
    v_exp_f32 v133, v133
    v_cvt_pk_bf16_f32 v160, v128, v129
    v_cvt_pk_bf16_f32 v161, v130, v131
    v_exp_f32 v134, v134
    v_exp_f32 v135, v135
    ds_read_b128 v[176:179], v208 offset:0
    v_exp_f32 v136, v136
    v_exp_f32 v137, v137
    v_cvt_pk_bf16_f32 v162, v132, v133
    v_cvt_pk_bf16_f32 v163, v134, v135
    v_exp_f32 v138, v138
    s_add_u32 m0, s35, 0
    s_add_u32 s34, s48, 81920
    buffer_load_dwordx4 v220, s[16:19], s34 offen nt lds
    v_exp_f32 v139, v139
    v_exp_f32 v140, v140
    v_exp_f32 v141, v141
    v_cvt_pk_bf16_f32 v164, v136, v137
    v_cvt_pk_bf16_f32 v165, v138, v139
    ds_read_b128 v[180:183], v209 offset:0
    v_exp_f32 v142, v142
    v_exp_f32 v143, v143
    v_cvt_pk_bf16_f32 v166, v140, v141
    v_cvt_pk_bf16_f32 v167, v142, v143
    s_cbranch_vccnz L_g22
    s_waitcnt vmcnt(8)
    s_barrier
L_g22:
    s_waitcnt lgkmcnt(0)
    s_setprio 0
    v_mfma_f32_16x16x32_bf16 v[128:131], v[176:179], v[64:67], v[240:243]
    ds_read_b64_tr_b16 v[144:145], v212 offset:32768
    v_mfma_f32_16x16x32_bf16 v[136:139], v[176:179], v[68:71], v[244:247]
    ds_read_b64_tr_b16 v[146:147], v212 offset:36864
    v_mfma_f32_16x16x32_bf16 v[128:131], v[180:183], v[72:75], v[128:131]
    ds_read_b64_tr_b16 v[148:149], v213 offset:32768
    v_mfma_f32_16x16x32_bf16 v[136:139], v[180:183], v[76:79], v[136:139]
    ds_read_b64_tr_b16 v[150:151], v213 offset:36864
    v_mfma_f32_16x16x32_bf16 v[128:131], v[184:187], v[80:83], v[128:131]
    ds_read_b64_tr_b16 v[152:153], v214 offset:32768
    v_mfma_f32_16x16x32_bf16 v[136:139], v[184:187], v[84:87], v[136:139]
    ds_read_b64_tr_b16 v[154:155], v214 offset:36864
    v_mfma_f32_16x16x32_bf16 v[128:131], v[188:191], v[88:91], v[128:131]
    ds_read_b64_tr_b16 v[156:157], v215 offset:32768
    v_mfma_f32_16x16x32_bf16 v[136:139], v[188:191], v[92:95], v[136:139]
    ds_read_b64_tr_b16 v[158:159], v215 offset:36864
    v_mfma_f32_16x16x32_bf16 v[132:135], v[192:195], v[64:67], v[240:243]
    s_setprio 1
    ds_read_b64_tr_b16 v[168:169], v216 offset:32768
    v_mfma_f32_16x16x32_bf16 v[140:143], v[192:195], v[68:71], v[244:247]
    ds_read_b64_tr_b16 v[170:171], v216 offset:36864
    v_mfma_f32_16x16x32_bf16 v[132:135], v[196:199], v[72:75], v[132:135]
    ds_read_b64_tr_b16 v[172:173], v217 offset:32768
    v_mfma_f32_16x16x32_bf16 v[140:143], v[196:199], v[76:79], v[140:143]
    ds_read_b64_tr_b16 v[174:175], v217 offset:36864
    v_mfma_f32_16x16x32_bf16 v[132:135], v[200:203], v[80:83], v[132:135]
    ds_read_b64_tr_b16 v[176:177], v218 offset:32768
    v_mfma_f32_16x16x32_bf16 v[140:143], v[200:203], v[84:87], v[140:143]
    ds_read_b64_tr_b16 v[178:179], v218 offset:36864
    v_mfma_f32_16x16x32_bf16 v[132:135], v[204:207], v[88:91], v[132:135]
    ds_read_b64_tr_b16 v[180:181], v219 offset:32768
    v_mfma_f32_16x16x32_bf16 v[140:143], v[204:207], v[92:95], v[140:143]
    ds_read_b64_tr_b16 v[182:183], v219 offset:36864
    v_mfma_f32_16x16x32_bf16 v[226:229], v[248:251], v[160:163], v[226:229]
    v_mfma_f32_16x16x32_bf16 v[252:255], v[248:251], v[164:167], v[252:255]
    s_waitcnt lgkmcnt(14)
    v_mfma_f32_16x16x32_bf16 v[0:3], v[144:147], v[160:163], v[0:3]
    v_mfma_f32_16x16x32_bf16 v[4:7], v[144:147], v[164:167], v[4:7]
    s_waitcnt lgkmcnt(12)
    v_mfma_f32_16x16x32_bf16 v[8:11], v[148:151], v[160:163], v[8:11]
    v_mfma_f32_16x16x32_bf16 v[12:15], v[148:151], v[164:167], v[12:15]
    ds_read_b128 v[184:187], v210 offset:8192
    s_waitcnt lgkmcnt(11)
    v_mfma_f32_16x16x32_bf16 v[16:19], v[152:155], v[160:163], v[16:19]
    v_mfma_f32_16x16x32_bf16 v[20:23], v[152:155], v[164:167], v[20:23]
    ds_read_b128 v[188:191], v211 offset:8192
    s_waitcnt lgkmcnt(10)
    v_mfma_f32_16x16x32_bf16 v[24:27], v[156:159], v[160:163], v[24:27]
    v_mfma_f32_16x16x32_bf16 v[28:31], v[156:159], v[164:167], v[28:31]
    ds_read_b128 v[192:195], v208 offset:12288
    s_waitcnt lgkmcnt(9)
    v_mfma_f32_16x16x32_bf16 v[32:35], v[168:171], v[160:163], v[32:35]
    v_mfma_f32_16x16x32_bf16 v[36:39], v[168:171], v[164:167], v[36:39]
    ds_read_b128 v[196:199], v209 offset:12288
    s_waitcnt lgkmcnt(8)
    v_mfma_f32_16x16x32_bf16 v[40:43], v[172:175], v[160:163], v[40:43]
    v_mfma_f32_16x16x32_bf16 v[44:47], v[172:175], v[164:167], v[44:47]
    ds_read_b128 v[200:203], v210 offset:12288
    s_waitcnt lgkmcnt(7)
    v_mfma_f32_16x16x32_bf16 v[48:51], v[176:179], v[160:163], v[48:51]
    v_mfma_f32_16x16x32_bf16 v[52:55], v[176:179], v[164:167], v[52:55]
    ds_read_b128 v[204:207], v211 offset:12288
    s_waitcnt lgkmcnt(6)
    v_mfma_f32_16x16x32_bf16 v[56:59], v[180:183], v[160:163], v[56:59]
    v_mfma_f32_16x16x32_bf16 v[60:63], v[180:183], v[164:167], v[60:63]
    s_setprio 3
    s_cbranch_vccz L_g23
    s_waitcnt vmcnt(4)
    s_barrier
L_g23:
    v_add_u32 v212, 40960, v212
    v_add_u32 v213, 40960, v213
    v_add_u32 v214, 40960, v214
    v_add_u32 v215, 40960, v215
    v_add_u32 v216, 40960, v216
    v_add_u32 v217, 40960, v217
    v_add_u32 v218, 40960, v218
    v_add_u32 v219, 40960, v219
    v_exp_f32 v128, v128
    v_exp_f32 v129, v129
    v_exp_f32 v130, v130
    v_exp_f32 v131, v131
    v_exp_f32 v132, v132
    s_add_u32 m0, s49, 155648
    s_add_u32 s34, s48, 73728
    buffer_load_dwordx4 v221, s[20:23], s34 offen nt lds
    v_exp_f32 v133, v133
    v_cvt_pk_bf16_f32 v160, v128, v129
    v_cvt_pk_bf16_f32 v161, v130, v131
    v_exp_f32 v134, v134
    v_exp_f32 v135, v135
    ds_read_b128 v[176:179], v208 offset:8192
    v_exp_f32 v136, v136
    v_exp_f32 v137, v137
    v_cvt_pk_bf16_f32 v162, v132, v133
    v_cvt_pk_bf16_f32 v163, v134, v135
    v_exp_f32 v138, v138
    s_add_u32 m0, s35, 8192
    s_add_u32 s34, s48, 90112
    buffer_load_dwordx4 v220, s[16:19], s34 offen nt lds
    v_exp_f32 v139, v139
    v_exp_f32 v140, v140
    v_exp_f32 v141, v141
    v_cvt_pk_bf16_f32 v164, v136, v137
    v_cvt_pk_bf16_f32 v165, v138, v139
    ds_read_b128 v[180:183], v209 offset:8192
    v_exp_f32 v142, v142
    v_exp_f32 v143, v143
    v_cvt_pk_bf16_f32 v166, v140, v141
    v_cvt_pk_bf16_f32 v167, v142, v143
    s_cbranch_vccnz L_g24
    s_waitcnt vmcnt(6)
    s_barrier
L_g24:
    s_waitcnt lgkmcnt(0)
    s_setprio 0
    v_mfma_f32_16x16x32_bf16 v[128:131], v[176:179], v[64:67], v[240:243]
    ds_read_b64_tr_b16 v[144:145], v212 offset:0
    v_mfma_f32_16x16x32_bf16 v[136:139], v[176:179], v[68:71], v[244:247]
    ds_read_b64_tr_b16 v[146:147], v212 offset:4096
    v_mfma_f32_16x16x32_bf16 v[128:131], v[180:183], v[72:75], v[128:131]
    ds_read_b64_tr_b16 v[148:149], v213 offset:0
    v_mfma_f32_16x16x32_bf16 v[136:139], v[180:183], v[76:79], v[136:139]
    ds_read_b64_tr_b16 v[150:151], v213 offset:4096
    v_mfma_f32_16x16x32_bf16 v[128:131], v[184:187], v[80:83], v[128:131]
    ds_read_b64_tr_b16 v[152:153], v214 offset:0
    v_mfma_f32_16x16x32_bf16 v[136:139], v[184:187], v[84:87], v[136:139]
    ds_read_b64_tr_b16 v[154:155], v214 offset:4096
    v_mfma_f32_16x16x32_bf16 v[128:131], v[188:191], v[88:91], v[128:131]
    ds_read_b64_tr_b16 v[156:157], v215 offset:0
    v_mfma_f32_16x16x32_bf16 v[136:139], v[188:191], v[92:95], v[136:139]
    ds_read_b64_tr_b16 v[158:159], v215 offset:4096
    v_mfma_f32_16x16x32_bf16 v[132:135], v[192:195], v[64:67], v[240:243]
    s_setprio 1
    ds_read_b64_tr_b16 v[168:169], v216 offset:0
    v_mfma_f32_16x16x32_bf16 v[140:143], v[192:195], v[68:71], v[244:247]
    ds_read_b64_tr_b16 v[170:171], v216 offset:4096
    v_mfma_f32_16x16x32_bf16 v[132:135], v[196:199], v[72:75], v[132:135]
    ds_read_b64_tr_b16 v[172:173], v217 offset:0
    v_mfma_f32_16x16x32_bf16 v[140:143], v[196:199], v[76:79], v[140:143]
    ds_read_b64_tr_b16 v[174:175], v217 offset:4096
    v_mfma_f32_16x16x32_bf16 v[132:135], v[200:203], v[80:83], v[132:135]
    ds_read_b64_tr_b16 v[176:177], v218 offset:0
    v_mfma_f32_16x16x32_bf16 v[140:143], v[200:203], v[84:87], v[140:143]
    ds_read_b64_tr_b16 v[178:179], v218 offset:4096
    v_mfma_f32_16x16x32_bf16 v[132:135], v[204:207], v[88:91], v[132:135]
    ds_read_b64_tr_b16 v[180:181], v219 offset:0
    v_mfma_f32_16x16x32_bf16 v[140:143], v[204:207], v[92:95], v[140:143]
    ds_read_b64_tr_b16 v[182:183], v219 offset:4096
    v_mfma_f32_16x16x32_bf16 v[226:229], v[248:251], v[160:163], v[226:229]
    v_mfma_f32_16x16x32_bf16 v[252:255], v[248:251], v[164:167], v[252:255]
    s_waitcnt lgkmcnt(14)
    v_mfma_f32_16x16x32_bf16 v[0:3], v[144:147], v[160:163], v[0:3]
    v_mfma_f32_16x16x32_bf16 v[4:7], v[144:147], v[164:167], v[4:7]
    s_waitcnt lgkmcnt(12)
    v_mfma_f32_16x16x32_bf16 v[8:11], v[148:151], v[160:163], v[8:11]
    v_mfma_f32_16x16x32_bf16 v[12:15], v[148:151], v[164:167], v[12:15]
    ds_read_b128 v[184:187], v210 offset:16384
    s_waitcnt lgkmcnt(11)
    v_mfma_f32_16x16x32_bf16 v[16:19], v[152:155], v[160:163], v[16:19]
    v_mfma_f32_16x16x32_bf16 v[20:23], v[152:155], v[164:167], v[20:23]
    ds_read_b128 v[188:191], v211 offset:16384
    s_waitcnt lgkmcnt(10)
    v_mfma_f32_16x16x32_bf16 v[24:27], v[156:159], v[160:163], v[24:27]
    v_mfma_f32_16x16x32_bf16 v[28:31], v[156:159], v[164:167], v[28:31]
    ds_read_b128 v[192:195], v208 offset:20480
    s_waitcnt lgkmcnt(9)
    v_mfma_f32_16x16x32_bf16 v[32:35], v[168:171], v[160:163], v[32:35]
    v_mfma_f32_16x16x32_bf16 v[36:39], v[168:171], v[164:167], v[36:39]
    ds_read_b128 v[196:199], v209 offset:20480
    s_waitcnt lgkmcnt(8)
    v_mfma_f32_16x16x32_bf16 v[40:43], v[172:175], v[160:163], v[40:43]
    v_mfma_f32_16x16x32_bf16 v[44:47], v[172:175], v[164:167], v[44:47]
    ds_read_b128 v[200:203], v210 offset:20480
    s_waitcnt lgkmcnt(7)
    v_mfma_f32_16x16x32_bf16 v[48:51], v[176:179], v[160:163], v[48:51]
    v_mfma_f32_16x16x32_bf16 v[52:55], v[176:179], v[164:167], v[52:55]
    ds_read_b128 v[204:207], v211 offset:20480
    s_waitcnt lgkmcnt(6)
    v_mfma_f32_16x16x32_bf16 v[56:59], v[180:183], v[160:163], v[56:59]
    v_mfma_f32_16x16x32_bf16 v[60:63], v[180:183], v[164:167], v[60:63]
    s_setprio 3
    v_exp_f32 v128, v128
    v_exp_f32 v129, v129
    v_exp_f32 v130, v130
    v_exp_f32 v131, v131
    v_exp_f32 v132, v132
    s_add_u32 m0, s35, 81920
    s_add_u32 s34, s48, 81920
    buffer_load_dwordx4 v221, s[20:23], s34 offen nt lds
    v_exp_f32 v133, v133
    v_cvt_pk_bf16_f32 v160, v128, v129
    v_cvt_pk_bf16_f32 v161, v130, v131
    v_exp_f32 v134, v134
    v_exp_f32 v135, v135
    ds_read_b128 v[176:179], v208 offset:16384
    v_exp_f32 v136, v136
    v_exp_f32 v137, v137
    v_cvt_pk_bf16_f32 v162, v132, v133
    v_cvt_pk_bf16_f32 v163, v134, v135
    v_exp_f32 v138, v138
    s_add_u32 m0, s35, 16384
    s_add_u32 s34, s48, 98304
    buffer_load_dwordx4 v220, s[16:19], s34 offen nt lds
    v_exp_f32 v139, v139
    v_exp_f32 v140, v140
    v_exp_f32 v141, v141
    v_cvt_pk_bf16_f32 v164, v136, v137
    v_cvt_pk_bf16_f32 v165, v138, v139
    ds_read_b128 v[180:183], v209 offset:16384
    v_exp_f32 v142, v142
    v_exp_f32 v143, v143
    v_cvt_pk_bf16_f32 v166, v140, v141
    v_cvt_pk_bf16_f32 v167, v142, v143
    s_waitcnt lgkmcnt(0)
    s_setprio 0
    v_mfma_f32_16x16x32_bf16 v[128:131], v[176:179], v[64:67], v[240:243]
    ds_read_b64_tr_b16 v[144:145], v212 offset:8192
    v_mfma_f32_16x16x32_bf16 v[136:139], v[176:179], v[68:71], v[244:247]
    ds_read_b64_tr_b16 v[146:147], v212 offset:12288
    v_mfma_f32_16x16x32_bf16 v[128:131], v[180:183], v[72:75], v[128:131]
    ds_read_b64_tr_b16 v[148:149], v213 offset:8192
    v_mfma_f32_16x16x32_bf16 v[136:139], v[180:183], v[76:79], v[136:139]
    ds_read_b64_tr_b16 v[150:151], v213 offset:12288
    v_mfma_f32_16x16x32_bf16 v[128:131], v[184:187], v[80:83], v[128:131]
    ds_read_b64_tr_b16 v[152:153], v214 offset:8192
    v_mfma_f32_16x16x32_bf16 v[136:139], v[184:187], v[84:87], v[136:139]
    ds_read_b64_tr_b16 v[154:155], v214 offset:12288
    v_mfma_f32_16x16x32_bf16 v[128:131], v[188:191], v[88:91], v[128:131]
    ds_read_b64_tr_b16 v[156:157], v215 offset:8192
    v_mfma_f32_16x16x32_bf16 v[136:139], v[188:191], v[92:95], v[136:139]
    ds_read_b64_tr_b16 v[158:159], v215 offset:12288
    v_mfma_f32_16x16x32_bf16 v[132:135], v[192:195], v[64:67], v[240:243]
    s_setprio 1
    ds_read_b64_tr_b16 v[168:169], v216 offset:8192
    v_mfma_f32_16x16x32_bf16 v[140:143], v[192:195], v[68:71], v[244:247]
    ds_read_b64_tr_b16 v[170:171], v216 offset:12288
    v_mfma_f32_16x16x32_bf16 v[132:135], v[196:199], v[72:75], v[132:135]
    ds_read_b64_tr_b16 v[172:173], v217 offset:8192
    v_mfma_f32_16x16x32_bf16 v[140:143], v[196:199], v[76:79], v[140:143]
    ds_read_b64_tr_b16 v[174:175], v217 offset:12288
    v_mfma_f32_16x16x32_bf16 v[132:135], v[200:203], v[80:83], v[132:135]
    ds_read_b64_tr_b16 v[176:177], v218 offset:8192
    v_mfma_f32_16x16x32_bf16 v[140:143], v[200:203], v[84:87], v[140:143]
    ds_read_b64_tr_b16 v[178:179], v218 offset:12288
    v_mfma_f32_16x16x32_bf16 v[132:135], v[204:207], v[88:91], v[132:135]
    ds_read_b64_tr_b16 v[180:181], v219 offset:8192
    v_mfma_f32_16x16x32_bf16 v[140:143], v[204:207], v[92:95], v[140:143]
    ds_read_b64_tr_b16 v[182:183], v219 offset:12288
    v_mfma_f32_16x16x32_bf16 v[226:229], v[248:251], v[160:163], v[226:229]
    v_mfma_f32_16x16x32_bf16 v[252:255], v[248:251], v[164:167], v[252:255]
    s_waitcnt lgkmcnt(14)
    v_mfma_f32_16x16x32_bf16 v[0:3], v[144:147], v[160:163], v[0:3]
    v_mfma_f32_16x16x32_bf16 v[4:7], v[144:147], v[164:167], v[4:7]
    s_waitcnt lgkmcnt(12)
    v_mfma_f32_16x16x32_bf16 v[8:11], v[148:151], v[160:163], v[8:11]
    v_mfma_f32_16x16x32_bf16 v[12:15], v[148:151], v[164:167], v[12:15]
    ds_read_b128 v[184:187], v210 offset:24576
    s_waitcnt lgkmcnt(11)
    v_mfma_f32_16x16x32_bf16 v[16:19], v[152:155], v[160:163], v[16:19]
    v_mfma_f32_16x16x32_bf16 v[20:23], v[152:155], v[164:167], v[20:23]
    ds_read_b128 v[188:191], v211 offset:24576
    s_waitcnt lgkmcnt(10)
    v_mfma_f32_16x16x32_bf16 v[24:27], v[156:159], v[160:163], v[24:27]
    v_mfma_f32_16x16x32_bf16 v[28:31], v[156:159], v[164:167], v[28:31]
    ds_read_b128 v[192:195], v208 offset:28672
    s_waitcnt lgkmcnt(9)
    v_mfma_f32_16x16x32_bf16 v[32:35], v[168:171], v[160:163], v[32:35]
    v_mfma_f32_16x16x32_bf16 v[36:39], v[168:171], v[164:167], v[36:39]
    ds_read_b128 v[196:199], v209 offset:28672
    s_waitcnt lgkmcnt(8)
    v_mfma_f32_16x16x32_bf16 v[40:43], v[172:175], v[160:163], v[40:43]
    v_mfma_f32_16x16x32_bf16 v[44:47], v[172:175], v[164:167], v[44:47]
    ds_read_b128 v[200:203], v210 offset:28672
    s_waitcnt lgkmcnt(7)
    v_mfma_f32_16x16x32_bf16 v[48:51], v[176:179], v[160:163], v[48:51]
    v_mfma_f32_16x16x32_bf16 v[52:55], v[176:179], v[164:167], v[52:55]
    ds_read_b128 v[204:207], v211 offset:28672
    s_waitcnt lgkmcnt(6)
    v_mfma_f32_16x16x32_bf16 v[56:59], v[180:183], v[160:163], v[56:59]
    v_mfma_f32_16x16x32_bf16 v[60:63], v[180:183], v[164:167], v[60:63]
    s_setprio 3
    s_cbranch_vccz L_g25
    s_waitcnt vmcnt(4)
    s_barrier
L_g25:
    v_exp_f32 v128, v128
    v_exp_f32 v129, v129
    v_exp_f32 v130, v130
    v_exp_f32 v131, v131
    s_add_u32 m0, s35, 90112
    s_add_u32 s34, s48, 90112
    buffer_load_dwordx4 v221, s[20:23], s34 offen nt lds
    v_exp_f32 v132, v132
    v_exp_f32 v133, v133
    v_cvt_pk_bf16_f32 v160, v128, v129
    v_cvt_pk_bf16_f32 v161, v130, v131
    ds_read_b128 v[176:179], v208 offset:24576
    v_exp_f32 v134, v134
    v_exp_f32 v135, v135
    v_exp_f32 v136, v136
    v_exp_f32 v137, v137
    s_add_u32 m0, s35, 24576
    s_add_u32 s34, s48, 106496
    buffer_load_dwordx4 v220, s[16:19], s34 offen nt lds
    v_cvt_pk_bf16_f32 v162, v132, v133
    v_cvt_pk_bf16_f32 v163, v134, v135
    v_exp_f32 v138, v138
    v_exp_f32 v139, v139
    ds_read_b128 v[180:183], v209 offset:24576
    v_exp_f32 v140, v140
    v_exp_f32 v141, v141
    v_cvt_pk_bf16_f32 v164, v136, v137
    v_cvt_pk_bf16_f32 v165, v138, v139
    buffer_load_dwordx4 v[96:99], v239, s[12:15], 0 offen offset:0 nt
    buffer_load_dwordx4 v[104:107], v239, s[12:15], 0 offen offset:64 nt
    v_exp_f32 v142, v142
    v_exp_f32 v143, v143
    v_cvt_pk_bf16_f32 v166, v140, v141
    v_cvt_pk_bf16_f32 v167, v142, v143
    s_cbranch_vccnz L_g26
    s_waitcnt vmcnt(8)
    s_barrier
L_g26:
    s_waitcnt lgkmcnt(0)
    s_setprio 0
    v_mfma_f32_16x16x32_bf16 v[128:131], v[176:179], v[64:67], v[240:243]
    ds_read_b64_tr_b16 v[144:145], v212 offset:16384
    v_mfma_f32_16x16x32_bf16 v[136:139], v[176:179], v[68:71], v[244:247]
    ds_read_b64_tr_b16 v[146:147], v212 offset:20480
    v_mfma_f32_16x16x32_bf16 v[128:131], v[180:183], v[72:75], v[128:131]
    ds_read_b64_tr_b16 v[148:149], v213 offset:16384
    v_mfma_f32_16x16x32_bf16 v[136:139], v[180:183], v[76:79], v[136:139]
    ds_read_b64_tr_b16 v[150:151], v213 offset:20480
    v_mfma_f32_16x16x32_bf16 v[128:131], v[184:187], v[80:83], v[128:131]
    ds_read_b64_tr_b16 v[152:153], v214 offset:16384
    v_mfma_f32_16x16x32_bf16 v[136:139], v[184:187], v[84:87], v[136:139]
    ds_read_b64_tr_b16 v[154:155], v214 offset:20480
    v_mfma_f32_16x16x32_bf16 v[128:131], v[188:191], v[88:91], v[128:131]
    ds_read_b64_tr_b16 v[156:157], v215 offset:16384
    v_mfma_f32_16x16x32_bf16 v[136:139], v[188:191], v[92:95], v[136:139]
    ds_read_b64_tr_b16 v[158:159], v215 offset:20480
    v_mfma_f32_16x16x32_bf16 v[132:135], v[192:195], v[64:67], v[240:243]
    s_setprio 1
    ds_read_b64_tr_b16 v[168:169], v216 offset:16384
    v_mfma_f32_16x16x32_bf16 v[140:143], v[192:195], v[68:71], v[244:247]
    ds_read_b64_tr_b16 v[170:171], v216 offset:20480
    v_mfma_f32_16x16x32_bf16 v[132:135], v[196:199], v[72:75], v[132:135]
    ds_read_b64_tr_b16 v[172:173], v217 offset:16384
    v_mfma_f32_16x16x32_bf16 v[140:143], v[196:199], v[76:79], v[140:143]
    ds_read_b64_tr_b16 v[174:175], v217 offset:20480
    v_mfma_f32_16x16x32_bf16 v[132:135], v[200:203], v[80:83], v[132:135]
    ds_read_b64_tr_b16 v[176:177], v218 offset:16384
    v_mfma_f32_16x16x32_bf16 v[140:143], v[200:203], v[84:87], v[140:143]
    ds_read_b64_tr_b16 v[178:179], v218 offset:20480
    v_mfma_f32_16x16x32_bf16 v[132:135], v[204:207], v[88:91], v[132:135]
    ds_read_b64_tr_b16 v[180:181], v219 offset:16384
    v_mfma_f32_16x16x32_bf16 v[140:143], v[204:207], v[92:95], v[140:143]
    ds_read_b64_tr_b16 v[182:183], v219 offset:20480
    v_mfma_f32_16x16x32_bf16 v[226:229], v[248:251], v[160:163], v[226:229]
    v_mfma_f32_16x16x32_bf16 v[252:255], v[248:251], v[164:167], v[252:255]
    s_waitcnt lgkmcnt(14)
    v_mfma_f32_16x16x32_bf16 v[0:3], v[144:147], v[160:163], v[0:3]
    v_mfma_f32_16x16x32_bf16 v[4:7], v[144:147], v[164:167], v[4:7]
    s_waitcnt lgkmcnt(12)
    v_mfma_f32_16x16x32_bf16 v[8:11], v[148:151], v[160:163], v[8:11]
    v_mfma_f32_16x16x32_bf16 v[12:15], v[148:151], v[164:167], v[12:15]
    ds_read_b128 v[184:187], v210 offset:32768
    s_waitcnt lgkmcnt(11)
    v_mfma_f32_16x16x32_bf16 v[16:19], v[152:155], v[160:163], v[16:19]
    v_mfma_f32_16x16x32_bf16 v[20:23], v[152:155], v[164:167], v[20:23]
    ds_read_b128 v[188:191], v211 offset:32768
    s_waitcnt lgkmcnt(10)
    v_mfma_f32_16x16x32_bf16 v[24:27], v[156:159], v[160:163], v[24:27]
    v_mfma_f32_16x16x32_bf16 v[28:31], v[156:159], v[164:167], v[28:31]
    ds_read_b128 v[192:195], v208 offset:36864
    s_waitcnt lgkmcnt(9)
    v_mfma_f32_16x16x32_bf16 v[32:35], v[168:171], v[160:163], v[32:35]
    v_mfma_f32_16x16x32_bf16 v[36:39], v[168:171], v[164:167], v[36:39]
    ds_read_b128 v[196:199], v209 offset:36864
    s_waitcnt lgkmcnt(8)
    v_mfma_f32_16x16x32_bf16 v[40:43], v[172:175], v[160:163], v[40:43]
    v_mfma_f32_16x16x32_bf16 v[44:47], v[172:175], v[164:167], v[44:47]
    ds_read_b128 v[200:203], v210 offset:36864
    s_waitcnt lgkmcnt(7)
    v_mfma_f32_16x16x32_bf16 v[48:51], v[176:179], v[160:163], v[48:51]
    v_mfma_f32_16x16x32_bf16 v[52:55], v[176:179], v[164:167], v[52:55]
    ds_read_b128 v[204:207], v211 offset:36864
    s_waitcnt lgkmcnt(6)
    v_mfma_f32_16x16x32_bf16 v[56:59], v[180:183], v[160:163], v[56:59]
    v_mfma_f32_16x16x32_bf16 v[60:63], v[180:183], v[164:167], v[60:63]
    s_setprio 3
    v_exp_f32 v128, v128
    v_exp_f32 v129, v129
    v_exp_f32 v130, v130
    v_exp_f32 v131, v131
    s_add_u32 m0, s35, 98304
    s_add_u32 s34, s48, 98304
    buffer_load_dwordx4 v221, s[20:23], s34 offen nt lds
    v_exp_f32 v132, v132
    v_exp_f32 v133, v133
    v_cvt_pk_bf16_f32 v160, v128, v129
    v_cvt_pk_bf16_f32 v161, v130, v131
    ds_read_b128 v[176:179], v208 offset:32768
    v_exp_f32 v134, v134
    v_exp_f32 v135, v135
    v_exp_f32 v136, v136
    v_exp_f32 v137, v137
    s_add_u32 m0, s35, 32768
    s_add_u32 s34, s48, 114688
    buffer_load_dwordx4 v220, s[16:19], s34 offen nt lds
    v_cvt_pk_bf16_f32 v162, v132, v133
    v_cvt_pk_bf16_f32 v163, v134, v135
    v_exp_f32 v138, v138
    v_exp_f32 v139, v139
    ds_read_b128 v[180:183], v209 offset:32768
    v_exp_f32 v140, v140
    v_exp_f32 v141, v141
    v_cvt_pk_bf16_f32 v164, v136, v137
    v_cvt_pk_bf16_f32 v165, v138, v139
    buffer_load_dwordx4 v[100:103], v239, s[12:15], 0 offen offset:256 nt
    buffer_load_dwordx4 v[108:111], v239, s[12:15], 0 offen offset:320 nt
    v_exp_f32 v142, v142
    v_exp_f32 v143, v143
    v_cvt_pk_bf16_f32 v166, v140, v141
    v_cvt_pk_bf16_f32 v167, v142, v143
    v_subrev_u32 v208, 40960, v208
    v_subrev_u32 v209, 40960, v209
    v_subrev_u32 v210, 40960, v210
    v_subrev_u32 v211, 40960, v211
    s_waitcnt lgkmcnt(0)
    s_setprio 0
    v_mfma_f32_16x16x32_bf16 v[128:131], v[176:179], v[64:67], v[240:243]
    ds_read_b64_tr_b16 v[144:145], v212 offset:24576
    v_mfma_f32_16x16x32_bf16 v[136:139], v[176:179], v[68:71], v[244:247]
    ds_read_b64_tr_b16 v[146:147], v212 offset:28672
    v_mfma_f32_16x16x32_bf16 v[128:131], v[180:183], v[72:75], v[128:131]
    ds_read_b64_tr_b16 v[148:149], v213 offset:24576
    v_mfma_f32_16x16x32_bf16 v[136:139], v[180:183], v[76:79], v[136:139]
    ds_read_b64_tr_b16 v[150:151], v213 offset:28672
    v_mfma_f32_16x16x32_bf16 v[128:131], v[184:187], v[80:83], v[128:131]
    ds_read_b64_tr_b16 v[152:153], v214 offset:24576
    v_mfma_f32_16x16x32_bf16 v[136:139], v[184:187], v[84:87], v[136:139]
    ds_read_b64_tr_b16 v[154:155], v214 offset:28672
    v_mfma_f32_16x16x32_bf16 v[128:131], v[188:191], v[88:91], v[128:131]
    ds_read_b64_tr_b16 v[156:157], v215 offset:24576
    v_mfma_f32_16x16x32_bf16 v[136:139], v[188:191], v[92:95], v[136:139]
    ds_read_b64_tr_b16 v[158:159], v215 offset:28672
    v_mfma_f32_16x16x32_bf16 v[132:135], v[192:195], v[64:67], v[240:243]
    s_setprio 1
    ds_read_b64_tr_b16 v[168:169], v216 offset:24576
    v_mfma_f32_16x16x32_bf16 v[140:143], v[192:195], v[68:71], v[244:247]
    ds_read_b64_tr_b16 v[170:171], v216 offset:28672
    v_mfma_f32_16x16x32_bf16 v[132:135], v[196:199], v[72:75], v[132:135]
    ds_read_b64_tr_b16 v[172:173], v217 offset:24576
    v_mfma_f32_16x16x32_bf16 v[140:143], v[196:199], v[76:79], v[140:143]
    ds_read_b64_tr_b16 v[174:175], v217 offset:28672
    v_mfma_f32_16x16x32_bf16 v[132:135], v[200:203], v[80:83], v[132:135]
    ds_read_b64_tr_b16 v[176:177], v218 offset:24576
    v_mfma_f32_16x16x32_bf16 v[140:143], v[200:203], v[84:87], v[140:143]
    ds_read_b64_tr_b16 v[178:179], v218 offset:28672
    v_mfma_f32_16x16x32_bf16 v[132:135], v[204:207], v[88:91], v[132:135]
    ds_read_b64_tr_b16 v[180:181], v219 offset:24576
    v_mfma_f32_16x16x32_bf16 v[140:143], v[204:207], v[92:95], v[140:143]
    ds_read_b64_tr_b16 v[182:183], v219 offset:28672
    v_mfma_f32_16x16x32_bf16 v[226:229], v[248:251], v[160:163], v[226:229]
    v_mfma_f32_16x16x32_bf16 v[252:255], v[248:251], v[164:167], v[252:255]
    s_waitcnt lgkmcnt(14)
    v_mfma_f32_16x16x32_bf16 v[0:3], v[144:147], v[160:163], v[0:3]
    v_mfma_f32_16x16x32_bf16 v[4:7], v[144:147], v[164:167], v[4:7]
    s_waitcnt lgkmcnt(12)
    v_mfma_f32_16x16x32_bf16 v[8:11], v[148:151], v[160:163], v[8:11]
    v_mfma_f32_16x16x32_bf16 v[12:15], v[148:151], v[164:167], v[12:15]
    ds_read_b128 v[184:187], v210 offset:0
    s_waitcnt lgkmcnt(11)
    v_mfma_f32_16x16x32_bf16 v[16:19], v[152:155], v[160:163], v[16:19]
    v_mfma_f32_16x16x32_bf16 v[20:23], v[152:155], v[164:167], v[20:23]
    ds_read_b128 v[188:191], v211 offset:0
    s_waitcnt lgkmcnt(10)
    v_mfma_f32_16x16x32_bf16 v[24:27], v[156:159], v[160:163], v[24:27]
    v_mfma_f32_16x16x32_bf16 v[28:31], v[156:159], v[164:167], v[28:31]
    ds_read_b128 v[192:195], v208 offset:4096
    s_waitcnt lgkmcnt(9)
    v_mfma_f32_16x16x32_bf16 v[32:35], v[168:171], v[160:163], v[32:35]
    v_mfma_f32_16x16x32_bf16 v[36:39], v[168:171], v[164:167], v[36:39]
    ds_read_b128 v[196:199], v209 offset:4096
    s_waitcnt lgkmcnt(8)
    v_mfma_f32_16x16x32_bf16 v[40:43], v[172:175], v[160:163], v[40:43]
    v_mfma_f32_16x16x32_bf16 v[44:47], v[172:175], v[164:167], v[44:47]
    ds_read_b128 v[200:203], v210 offset:4096
    s_waitcnt lgkmcnt(7)
    v_mfma_f32_16x16x32_bf16 v[48:51], v[176:179], v[160:163], v[48:51]
    v_mfma_f32_16x16x32_bf16 v[52:55], v[176:179], v[164:167], v[52:55]
    ds_read_b128 v[204:207], v211 offset:4096
    s_waitcnt lgkmcnt(6)
    v_mfma_f32_16x16x32_bf16 v[56:59], v[180:183], v[160:163], v[56:59]
    v_mfma_f32_16x16x32_bf16 v[60:63], v[180:183], v[164:167], v[60:63]
    s_setprio 3
    s_cbranch_vccz L_g27
    s_waitcnt vmcnt(8)
    s_barrier
L_g27:
    v_exp_f32 v128, v128
    v_exp_f32 v129, v129
    v_exp_f32 v130, v130
    v_exp_f32 v131, v131
    v_exp_f32 v132, v132
    s_add_u32 m0, s35, 106496
    s_add_u32 s34, s48, 106496
    buffer_load_dwordx4 v221, s[20:23], s34 offen nt lds
    v_exp_f32 v133, v133
    v_cvt_pk_bf16_f32 v160, v128, v129
    v_cvt_pk_bf16_f32 v161, v130, v131
    v_exp_f32 v134, v134
    v_exp_f32 v135, v135
    ds_read_b128 v[176:179], v208 offset:0
    v_exp_f32 v136, v136
    v_exp_f32 v137, v137
    v_cvt_pk_bf16_f32 v162, v132, v133
    v_cvt_pk_bf16_f32 v163, v134, v135
    v_exp_f32 v138, v138
    s_add_u32 m0, s35, 40960
    s_add_u32 s34, s48, 122880
    buffer_load_dwordx4 v220, s[16:19], s34 offen nt lds
    v_exp_f32 v139, v139
    v_exp_f32 v140, v140
    v_exp_f32 v141, v141
    v_cvt_pk_bf16_f32 v164, v136, v137
    v_cvt_pk_bf16_f32 v165, v138, v139
    ds_read_b128 v[180:183], v209 offset:0
    v_exp_f32 v142, v142
    v_exp_f32 v143, v143
    v_cvt_pk_bf16_f32 v166, v140, v141
    v_cvt_pk_bf16_f32 v167, v142, v143
    s_cbranch_vccnz L_g28
    s_waitcnt vmcnt(10)
    s_barrier
L_g28:
    s_waitcnt lgkmcnt(0)
    s_setprio 0
    v_mfma_f32_16x16x32_bf16 v[128:131], v[176:179], v[64:67], v[240:243]
    ds_read_b64_tr_b16 v[144:145], v212 offset:32768
    v_mfma_f32_16x16x32_bf16 v[136:139], v[176:179], v[68:71], v[244:247]
    ds_read_b64_tr_b16 v[146:147], v212 offset:36864
    v_mfma_f32_16x16x32_bf16 v[128:131], v[180:183], v[72:75], v[128:131]
    ds_read_b64_tr_b16 v[148:149], v213 offset:32768
    v_mfma_f32_16x16x32_bf16 v[136:139], v[180:183], v[76:79], v[136:139]
    ds_read_b64_tr_b16 v[150:151], v213 offset:36864
    v_mfma_f32_16x16x32_bf16 v[128:131], v[184:187], v[80:83], v[128:131]
    ds_read_b64_tr_b16 v[152:153], v214 offset:32768
    v_mfma_f32_16x16x32_bf16 v[136:139], v[184:187], v[84:87], v[136:139]
    ds_read_b64_tr_b16 v[154:155], v214 offset:36864
    v_mfma_f32_16x16x32_bf16 v[128:131], v[188:191], v[88:91], v[128:131]
    ds_read_b64_tr_b16 v[156:157], v215 offset:32768
    v_mfma_f32_16x16x32_bf16 v[136:139], v[188:191], v[92:95], v[136:139]
    ds_read_b64_tr_b16 v[158:159], v215 offset:36864
    v_mfma_f32_16x16x32_bf16 v[132:135], v[192:195], v[64:67], v[240:243]
    s_setprio 1
    ds_read_b64_tr_b16 v[168:169], v216 offset:32768
    v_mfma_f32_16x16x32_bf16 v[140:143], v[192:195], v[68:71], v[244:247]
    ds_read_b64_tr_b16 v[170:171], v216 offset:36864
    v_mfma_f32_16x16x32_bf16 v[132:135], v[196:199], v[72:75], v[132:135]
    ds_read_b64_tr_b16 v[172:173], v217 offset:32768
    v_mfma_f32_16x16x32_bf16 v[140:143], v[196:199], v[76:79], v[140:143]
    ds_read_b64_tr_b16 v[174:175], v217 offset:36864
    v_mfma_f32_16x16x32_bf16 v[132:135], v[200:203], v[80:83], v[132:135]
    ds_read_b64_tr_b16 v[176:177], v218 offset:32768
    v_mfma_f32_16x16x32_bf16 v[140:143], v[200:203], v[84:87], v[140:143]
    ds_read_b64_tr_b16 v[178:179], v218 offset:36864
    v_mfma_f32_16x16x32_bf16 v[132:135], v[204:207], v[88:91], v[132:135]
    ds_read_b64_tr_b16 v[180:181], v219 offset:32768
    v_mfma_f32_16x16x32_bf16 v[140:143], v[204:207], v[92:95], v[140:143]
    ds_read_b64_tr_b16 v[182:183], v219 offset:36864
    v_mfma_f32_16x16x32_bf16 v[226:229], v[248:251], v[160:163], v[226:229]
    v_mfma_f32_16x16x32_bf16 v[252:255], v[248:251], v[164:167], v[252:255]
    s_waitcnt lgkmcnt(14)
    v_mfma_f32_16x16x32_bf16 v[0:3], v[144:147], v[160:163], v[0:3]
    v_mfma_f32_16x16x32_bf16 v[4:7], v[144:147], v[164:167], v[4:7]
    s_waitcnt lgkmcnt(12)
    v_mfma_f32_16x16x32_bf16 v[8:11], v[148:151], v[160:163], v[8:11]
    v_mfma_f32_16x16x32_bf16 v[12:15], v[148:151], v[164:167], v[12:15]
    ds_read_b128 v[184:187], v210 offset:8192
    s_waitcnt lgkmcnt(11)
    v_mfma_f32_16x16x32_bf16 v[16:19], v[152:155], v[160:163], v[16:19]
    v_mfma_f32_16x16x32_bf16 v[20:23], v[152:155], v[164:167], v[20:23]
    ds_read_b128 v[188:191], v211 offset:8192
    s_waitcnt lgkmcnt(10)
    v_mfma_f32_16x16x32_bf16 v[24:27], v[156:159], v[160:163], v[24:27]
    v_mfma_f32_16x16x32_bf16 v[28:31], v[156:159], v[164:167], v[28:31]
    ds_read_b128 v[192:195], v208 offset:12288
    s_waitcnt lgkmcnt(9)
    v_mfma_f32_16x16x32_bf16 v[32:35], v[168:171], v[160:163], v[32:35]
    v_mfma_f32_16x16x32_bf16 v[36:39], v[168:171], v[164:167], v[36:39]
    ds_read_b128 v[196:199], v209 offset:12288
    s_waitcnt lgkmcnt(8)
    v_mfma_f32_16x16x32_bf16 v[40:43], v[172:175], v[160:163], v[40:43]
    v_mfma_f32_16x16x32_bf16 v[44:47], v[172:175], v[164:167], v[44:47]
    ds_read_b128 v[200:203], v210 offset:12288
    s_waitcnt lgkmcnt(7)
    v_mfma_f32_16x16x32_bf16 v[48:51], v[176:179], v[160:163], v[48:51]
    v_mfma_f32_16x16x32_bf16 v[52:55], v[176:179], v[164:167], v[52:55]
    ds_read_b128 v[204:207], v211 offset:12288
    s_waitcnt lgkmcnt(6)
    v_mfma_f32_16x16x32_bf16 v[56:59], v[180:183], v[160:163], v[56:59]
    v_mfma_f32_16x16x32_bf16 v[60:63], v[180:183], v[164:167], v[60:63]
    s_setprio 3
    v_subrev_u32 v212, 40960, v212
    v_subrev_u32 v213, 40960, v213
    v_subrev_u32 v214, 40960, v214
    v_subrev_u32 v215, 40960, v215
    v_subrev_u32 v216, 40960, v216
    v_subrev_u32 v217, 40960, v217
    v_subrev_u32 v218, 40960, v218
    v_subrev_u32 v219, 40960, v219
    v_exp_f32 v128, v128
    v_exp_f32 v129, v129
    v_exp_f32 v130, v130
    v_exp_f32 v131, v131
    s_add_u32 m0, s35, 114688
    s_add_u32 s34, s48, 114688
    buffer_load_dwordx4 v221, s[20:23], s34 offen nt lds
    v_exp_f32 v132, v132
    v_exp_f32 v133, v133
    v_cvt_pk_bf16_f32 v160, v128, v129
    v_cvt_pk_bf16_f32 v161, v130, v131
    ds_read_b128 v[176:179], v208 offset:8192
    v_exp_f32 v134, v134
    v_exp_f32 v135, v135
    v_exp_f32 v136, v136
    v_exp_f32 v137, v137
    s_add_u32 m0, s35, 49152
    s_add_u32 s34, s48, 131072
    buffer_load_dwordx4 v220, s[16:19], s34 offen nt lds
    v_cvt_pk_bf16_f32 v162, v132, v133
    v_cvt_pk_bf16_f32 v163, v134, v135
    v_exp_f32 v138, v138
    v_exp_f32 v139, v139
    ds_read_b128 v[180:183], v209 offset:8192
    v_exp_f32 v140, v140
    v_exp_f32 v141, v141
    v_cvt_pk_bf16_f32 v164, v136, v137
    v_cvt_pk_bf16_f32 v165, v138, v139
    buffer_load_dwordx4 v[112:115], v239, s[12:15], 0 offen offset:128 nt
    buffer_load_dwordx4 v[120:123], v239, s[12:15], 0 offen offset:192 nt
    v_exp_f32 v142, v142
    v_exp_f32 v143, v143
    v_cvt_pk_bf16_f32 v166, v140, v141
    v_cvt_pk_bf16_f32 v167, v142, v143
    s_waitcnt vmcnt(11)
    v_lshlrev_b32 v234, 16, v96
    v_and_b32 v235, 0xffff0000, v96
    v_mul_f32 v234, s32, v234
    v_mul_f32 v235, s32, v235
    v_lshlrev_b32 v236, 16, v97
    v_and_b32 v237, 0xffff0000, v97
    v_mul_f32 v236, s32, v236
    v_mul_f32 v237, s32, v237
    v_cvt_pk_bf16_f32 v96, v234, v235
    v_lshlrev_b32 v234, 16, v98
    v_and_b32 v235, 0xffff0000, v98
    v_mul_f32 v234, s32, v234
    v_mul_f32 v235, s32, v235
    v_cvt_pk_bf16_f32 v97, v236, v237
    v_lshlrev_b32 v236, 16, v99
    v_and_b32 v237, 0xffff0000, v99
    v_mul_f32 v236, s32, v236
    v_mul_f32 v237, s32, v237
    v_cvt_pk_bf16_f32 v98, v234, v235
    v_cvt_pk_bf16_f32 v99, v236, v237
    s_waitcnt vmcnt(10)
    v_lshlrev_b32 v234, 16, v104
    v_and_b32 v235, 0xffff0000, v104
    v_mul_f32 v234, s32, v234
    v_mul_f32 v235, s32, v235
    v_lshlrev_b32 v236, 16, v105
    v_and_b32 v237, 0xffff0000, v105
    v_mul_f32 v236, s32, v236
    v_mul_f32 v237, s32, v237
    v_cvt_pk_bf16_f32 v104, v234, v235
    v_lshlrev_b32 v234, 16, v106
    v_and_b32 v235, 0xffff0000, v106
    v_mul_f32 v234, s32, v234
    v_mul_f32 v235, s32, v235
    v_cvt_pk_bf16_f32 v105, v236, v237
    v_lshlrev_b32 v236, 16, v107
    v_and_b32 v237, 0xffff0000, v107
    v_mul_f32 v236, s32, v236
    v_mul_f32 v237, s32, v237
    v_cvt_pk_bf16_f32 v106, v234, v235
    v_cvt_pk_bf16_f32 v107, v236, v237
    s_waitcnt lgkmcnt(0)
    s_setprio 0
    v_mfma_f32_16x16x32_bf16 v[128:131], v[176:179], v[64:67], v[240:243]
    ds_read_b64_tr_b16 v[144:145], v212 offset:0
    v_mfma_f32_16x16x32_bf16 v[136:139], v[176:179], v[68:71], v[244:247]
    ds_read_b64_tr_b16 v[146:147], v212 offset:4096
    v_mfma_f32_16x16x32_bf16 v[128:131], v[180:183], v[72:75], v[128:131]
    ds_read_b64_tr_b16 v[148:149], v213 offset:0
    v_mfma_f32_16x16x32_bf16 v[136:139], v[180:183], v[76:79], v[136:139]
    ds_read_b64_tr_b16 v[150:151], v213 offset:4096
    v_mfma_f32_16x16x32_bf16 v[128:131], v[184:187], v[80:83], v[128:131]
    ds_read_b64_tr_b16 v[152:153], v214 offset:0
    v_mfma_f32_16x16x32_bf16 v[136:139], v[184:187], v[84:87], v[136:139]
    ds_read_b64_tr_b16 v[154:155], v214 offset:4096
    v_mfma_f32_16x16x32_bf16 v[128:131], v[188:191], v[88:91], v[128:131]
    ds_read_b64_tr_b16 v[156:157], v215 offset:0
    v_mfma_f32_16x16x32_bf16 v[136:139], v[188:191], v[92:95], v[136:139]
    ds_read_b64_tr_b16 v[158:159], v215 offset:4096
    v_mfma_f32_16x16x32_bf16 v[132:135], v[192:195], v[64:67], v[240:243]
    s_setprio 1
    ds_read_b64_tr_b16 v[168:169], v216 offset:0
    v_mfma_f32_16x16x32_bf16 v[140:143], v[192:195], v[68:71], v[244:247]
    ds_read_b64_tr_b16 v[170:171], v216 offset:4096
    v_mfma_f32_16x16x32_bf16 v[132:135], v[196:199], v[72:75], v[132:135]
    ds_read_b64_tr_b16 v[172:173], v217 offset:0
    v_mfma_f32_16x16x32_bf16 v[140:143], v[196:199], v[76:79], v[140:143]
    ds_read_b64_tr_b16 v[174:175], v217 offset:4096
    v_mfma_f32_16x16x32_bf16 v[132:135], v[200:203], v[80:83], v[132:135]
    ds_read_b64_tr_b16 v[176:177], v218 offset:0
    v_mfma_f32_16x16x32_bf16 v[140:143], v[200:203], v[84:87], v[140:143]
    ds_read_b64_tr_b16 v[178:179], v218 offset:4096
    v_mfma_f32_16x16x32_bf16 v[132:135], v[204:207], v[88:91], v[132:135]
    ds_read_b64_tr_b16 v[180:181], v219 offset:0
    v_mfma_f32_16x16x32_bf16 v[140:143], v[204:207], v[92:95], v[140:143]
    ds_read_b64_tr_b16 v[182:183], v219 offset:4096
    v_mfma_f32_16x16x32_bf16 v[226:229], v[248:251], v[160:163], v[226:229]
    v_mfma_f32_16x16x32_bf16 v[252:255], v[248:251], v[164:167], v[252:255]
    s_waitcnt lgkmcnt(14)
    v_mfma_f32_16x16x32_bf16 v[0:3], v[144:147], v[160:163], v[0:3]
    v_mfma_f32_16x16x32_bf16 v[4:7], v[144:147], v[164:167], v[4:7]
    s_waitcnt lgkmcnt(12)
    v_mfma_f32_16x16x32_bf16 v[8:11], v[148:151], v[160:163], v[8:11]
    v_mfma_f32_16x16x32_bf16 v[12:15], v[148:151], v[164:167], v[12:15]
    ds_read_b128 v[184:187], v210 offset:16384
    s_waitcnt lgkmcnt(11)
    v_mfma_f32_16x16x32_bf16 v[16:19], v[152:155], v[160:163], v[16:19]
    v_mfma_f32_16x16x32_bf16 v[20:23], v[152:155], v[164:167], v[20:23]
    ds_read_b128 v[188:191], v211 offset:16384
    s_waitcnt lgkmcnt(10)
    v_mfma_f32_16x16x32_bf16 v[24:27], v[156:159], v[160:163], v[24:27]
    v_mfma_f32_16x16x32_bf16 v[28:31], v[156:159], v[164:167], v[28:31]
    ds_read_b128 v[192:195], v208 offset:20480
    s_waitcnt lgkmcnt(9)
    v_mfma_f32_16x16x32_bf16 v[32:35], v[168:171], v[160:163], v[32:35]
    v_mfma_f32_16x16x32_bf16 v[36:39], v[168:171], v[164:167], v[36:39]
    ds_read_b128 v[196:199], v209 offset:20480
    s_waitcnt lgkmcnt(8)
    v_mfma_f32_16x16x32_bf16 v[40:43], v[172:175], v[160:163], v[40:43]
    v_mfma_f32_16x16x32_bf16 v[44:47], v[172:175], v[164:167], v[44:47]
    ds_read_b128 v[200:203], v210 offset:20480
    s_waitcnt lgkmcnt(7)
    v_mfma_f32_16x16x32_bf16 v[48:51], v[176:179], v[160:163], v[48:51]
    v_mfma_f32_16x16x32_bf16 v[52:55], v[176:179], v[164:167], v[52:55]
    ds_read_b128 v[204:207], v211 offset:20480
    s_waitcnt lgkmcnt(6)
    v_mfma_f32_16x16x32_bf16 v[56:59], v[180:183], v[160:163], v[56:59]
    v_mfma_f32_16x16x32_bf16 v[60:63], v[180:183], v[164:167], v[60:63]
    s_setprio 3
    s_cbranch_vccz L_g29
    s_waitcnt vmcnt(8)
    s_barrier
L_g29:
    v_exp_f32 v128, v128
    v_exp_f32 v129, v129
    v_exp_f32 v130, v130
    v_exp_f32 v131, v131
    s_add_u32 m0, s35, 122880
    s_add_u32 s34, s48, 122880
    buffer_load_dwordx4 v221, s[20:23], s34 offen nt lds
    v_exp_f32 v132, v132
    v_exp_f32 v133, v133
    v_cvt_pk_bf16_f32 v160, v128, v129
    v_cvt_pk_bf16_f32 v161, v130, v131
    ds_read_b128 v[176:179], v208 offset:16384
    v_exp_f32 v134, v134
    v_exp_f32 v135, v135
    v_exp_f32 v136, v136
    v_exp_f32 v137, v137
    s_add_u32 m0, s35, 57344
    s_add_u32 s34, s48, 139264
    buffer_load_dwordx4 v220, s[16:19], s34 offen nt lds
    v_cvt_pk_bf16_f32 v162, v132, v133
    v_cvt_pk_bf16_f32 v163, v134, v135
    v_exp_f32 v138, v138
    v_exp_f32 v139, v139
    ds_read_b128 v[180:183], v209 offset:16384
    v_exp_f32 v140, v140
    v_exp_f32 v141, v141
    v_cvt_pk_bf16_f32 v164, v136, v137
    v_cvt_pk_bf16_f32 v165, v138, v139
    buffer_load_dwordx4 v[116:119], v239, s[12:15], 0 offen offset:384 nt
    buffer_load_dwordx4 v[124:127], v239, s[12:15], 0 offen offset:448 nt
    v_exp_f32 v142, v142
    v_exp_f32 v143, v143
    v_cvt_pk_bf16_f32 v166, v140, v141
    v_cvt_pk_bf16_f32 v167, v142, v143
    s_waitcnt vmcnt(11)
    v_lshlrev_b32 v234, 16, v100
    v_and_b32 v235, 0xffff0000, v100
    v_mul_f32 v234, s32, v234
    v_mul_f32 v235, s32, v235
    v_lshlrev_b32 v236, 16, v101
    v_and_b32 v237, 0xffff0000, v101
    v_mul_f32 v236, s32, v236
    v_mul_f32 v237, s32, v237
    v_cvt_pk_bf16_f32 v100, v234, v235
    v_lshlrev_b32 v234, 16, v102
    v_and_b32 v235, 0xffff0000, v102
    v_mul_f32 v234, s32, v234
    v_mul_f32 v235, s32, v235
    v_cvt_pk_bf16_f32 v101, v236, v237
    v_lshlrev_b32 v236, 16, v103
    v_and_b32 v237, 0xffff0000, v103
    v_mul_f32 v236, s32, v236
    v_mul_f32 v237, s32, v237
    v_cvt_pk_bf16_f32 v102, v234, v235
    v_cvt_pk_bf16_f32 v103, v236, v237
    s_cbranch_vccnz L_g30
    s_barrier
L_g30:
    s_waitcnt lgkmcnt(0)
    s_setprio 0
    v_mfma_f32_16x16x32_bf16 v[128:131], v[176:179], v[64:67], v[240:243]
    ds_read_b64_tr_b16 v[144:145], v212 offset:8192
    v_mfma_f32_16x16x32_bf16 v[136:139], v[176:179], v[68:71], v[244:247]
    ds_read_b64_tr_b16 v[146:147], v212 offset:12288
    v_mfma_f32_16x16x32_bf16 v[128:131], v[180:183], v[72:75], v[128:131]
    ds_read_b64_tr_b16 v[148:149], v213 offset:8192
    v_mfma_f32_16x16x32_bf16 v[136:139], v[180:183], v[76:79], v[136:139]
    ds_read_b64_tr_b16 v[150:151], v213 offset:12288
    v_mfma_f32_16x16x32_bf16 v[128:131], v[184:187], v[80:83], v[128:131]
    ds_read_b64_tr_b16 v[152:153], v214 offset:8192
    v_mfma_f32_16x16x32_bf16 v[136:139], v[184:187], v[84:87], v[136:139]
    ds_read_b64_tr_b16 v[154:155], v214 offset:12288
    v_mfma_f32_16x16x32_bf16 v[128:131], v[188:191], v[88:91], v[128:131]
    ds_read_b64_tr_b16 v[156:157], v215 offset:8192
    v_mfma_f32_16x16x32_bf16 v[136:139], v[188:191], v[92:95], v[136:139]
    ds_read_b64_tr_b16 v[158:159], v215 offset:12288
    v_mfma_f32_16x16x32_bf16 v[132:135], v[192:195], v[64:67], v[240:243]
    s_setprio 1
    ds_read_b64_tr_b16 v[168:169], v216 offset:8192
    v_mfma_f32_16x16x32_bf16 v[140:143], v[192:195], v[68:71], v[244:247]
    ds_read_b64_tr_b16 v[170:171], v216 offset:12288
    v_mfma_f32_16x16x32_bf16 v[132:135], v[196:199], v[72:75], v[132:135]
    ds_read_b64_tr_b16 v[172:173], v217 offset:8192
    v_mfma_f32_16x16x32_bf16 v[140:143], v[196:199], v[76:79], v[140:143]
    ds_read_b64_tr_b16 v[174:175], v217 offset:12288
    v_mfma_f32_16x16x32_bf16 v[132:135], v[200:203], v[80:83], v[132:135]
    ds_read_b64_tr_b16 v[176:177], v218 offset:8192
    v_mfma_f32_16x16x32_bf16 v[140:143], v[200:203], v[84:87], v[140:143]
    ds_read_b64_tr_b16 v[178:179], v218 offset:12288
    v_mfma_f32_16x16x32_bf16 v[132:135], v[204:207], v[88:91], v[132:135]
    ds_read_b64_tr_b16 v[180:181], v219 offset:8192
    v_mfma_f32_16x16x32_bf16 v[140:143], v[204:207], v[92:95], v[140:143]
    ds_read_b64_tr_b16 v[182:183], v219 offset:12288
    v_mfma_f32_16x16x32_bf16 v[226:229], v[248:251], v[160:163], v[226:229]
    v_mfma_f32_16x16x32_bf16 v[252:255], v[248:251], v[164:167], v[252:255]
    s_waitcnt lgkmcnt(14)
    v_mfma_f32_16x16x32_bf16 v[0:3], v[144:147], v[160:163], v[0:3]
    v_mfma_f32_16x16x32_bf16 v[4:7], v[144:147], v[164:167], v[4:7]
    s_waitcnt lgkmcnt(12)
    v_mfma_f32_16x16x32_bf16 v[8:11], v[148:151], v[160:163], v[8:11]
    v_mfma_f32_16x16x32_bf16 v[12:15], v[148:151], v[164:167], v[12:15]
    ds_read_b128 v[184:187], v210 offset:24576
    s_waitcnt lgkmcnt(11)
    v_mfma_f32_16x16x32_bf16 v[16:19], v[152:155], v[160:163], v[16:19]
    v_mfma_f32_16x16x32_bf16 v[20:23], v[152:155], v[164:167], v[20:23]
    ds_read_b128 v[188:191], v211 offset:24576
    s_waitcnt lgkmcnt(10)
    v_mfma_f32_16x16x32_bf16 v[24:27], v[156:159], v[160:163], v[24:27]
    v_mfma_f32_16x16x32_bf16 v[28:31], v[156:159], v[164:167], v[28:31]
    ds_read_b128 v[192:195], v208 offset:28672
    s_waitcnt lgkmcnt(9)
    v_mfma_f32_16x16x32_bf16 v[32:35], v[168:171], v[160:163], v[32:35]
    v_mfma_f32_16x16x32_bf16 v[36:39], v[168:171], v[164:167], v[36:39]
    ds_read_b128 v[196:199], v209 offset:28672
    s_waitcnt lgkmcnt(8)
    v_mfma_f32_16x16x32_bf16 v[40:43], v[172:175], v[160:163], v[40:43]
    v_mfma_f32_16x16x32_bf16 v[44:47], v[172:175], v[164:167], v[44:47]
    ds_read_b128 v[200:203], v210 offset:28672
    s_waitcnt lgkmcnt(7)
    v_mfma_f32_16x16x32_bf16 v[48:51], v[176:179], v[160:163], v[48:51]
    v_mfma_f32_16x16x32_bf16 v[52:55], v[176:179], v[164:167], v[52:55]
    ds_read_b128 v[204:207], v211 offset:28672
    s_waitcnt lgkmcnt(6)
    v_mfma_f32_16x16x32_bf16 v[56:59], v[180:183], v[160:163], v[56:59]
    v_mfma_f32_16x16x32_bf16 v[60:63], v[180:183], v[164:167], v[60:63]
    s_setprio 3
    v_exp_f32 v128, v128
    v_exp_f32 v129, v129
    v_exp_f32 v130, v130
    v_exp_f32 v131, v131
    v_exp_f32 v132, v132
    s_add_u32 m0, s35, 131072
    s_add_u32 s34, s48, 131072
    buffer_load_dwordx4 v221, s[20:23], s34 offen nt lds
    v_exp_f32 v133, v133
    v_cvt_pk_bf16_f32 v160, v128, v129
    v_cvt_pk_bf16_f32 v161, v130, v131
    v_exp_f32 v134, v134
    v_exp_f32 v135, v135
    ds_read_b128 v[176:179], v208 offset:24576
    v_exp_f32 v136, v136
    v_exp_f32 v137, v137
    v_cvt_pk_bf16_f32 v162, v132, v133
    v_cvt_pk_bf16_f32 v163, v134, v135
    v_exp_f32 v138, v138
    s_add_u32 m0, s49, 65536
    s_add_u32 s34, s48, 147456
    buffer_load_dwordx4 v220, s[16:19], s34 offen nt lds
    v_exp_f32 v139, v139
    v_exp_f32 v140, v140
    v_exp_f32 v141, v141
    v_cvt_pk_bf16_f32 v164, v136, v137
    v_cvt_pk_bf16_f32 v165, v138, v139
    ds_read_b128 v[180:183], v209 offset:24576
    v_exp_f32 v142, v142
    v_exp_f32 v143, v143
    v_cvt_pk_bf16_f32 v166, v140, v141
    v_cvt_pk_bf16_f32 v167, v142, v143
    s_waitcnt vmcnt(12)
    v_lshlrev_b32 v234, 16, v108
    v_and_b32 v235, 0xffff0000, v108
    v_mul_f32 v234, s32, v234
    v_mul_f32 v235, s32, v235
    v_lshlrev_b32 v236, 16, v109
    v_and_b32 v237, 0xffff0000, v109
    v_mul_f32 v236, s32, v236
    v_mul_f32 v237, s32, v237
    v_cvt_pk_bf16_f32 v108, v234, v235
    v_lshlrev_b32 v234, 16, v110
    v_and_b32 v235, 0xffff0000, v110
    v_mul_f32 v234, s32, v234
    v_mul_f32 v235, s32, v235
    v_cvt_pk_bf16_f32 v109, v236, v237
    v_lshlrev_b32 v236, 16, v111
    v_and_b32 v237, 0xffff0000, v111
    v_mul_f32 v236, s32, v236
    v_mul_f32 v237, s32, v237
    v_cvt_pk_bf16_f32 v110, v234, v235
    v_cvt_pk_bf16_f32 v111, v236, v237
    s_waitcnt lgkmcnt(0)
    s_setprio 0
    v_mfma_f32_16x16x32_bf16 v[128:131], v[176:179], v[64:67], v[240:243]
    ds_read_b64_tr_b16 v[144:145], v212 offset:16384
    v_mfma_f32_16x16x32_bf16 v[136:139], v[176:179], v[68:71], v[244:247]
    ds_read_b64_tr_b16 v[146:147], v212 offset:20480
    v_mfma_f32_16x16x32_bf16 v[128:131], v[180:183], v[72:75], v[128:131]
    ds_read_b64_tr_b16 v[148:149], v213 offset:16384
    v_mfma_f32_16x16x32_bf16 v[136:139], v[180:183], v[76:79], v[136:139]
    ds_read_b64_tr_b16 v[150:151], v213 offset:20480
    v_mfma_f32_16x16x32_bf16 v[128:131], v[184:187], v[80:83], v[128:131]
    ds_read_b64_tr_b16 v[152:153], v214 offset:16384
    v_mfma_f32_16x16x32_bf16 v[136:139], v[184:187], v[84:87], v[136:139]
    ds_read_b64_tr_b16 v[154:155], v214 offset:20480
    v_mfma_f32_16x16x32_bf16 v[128:131], v[188:191], v[88:91], v[128:131]
    ds_read_b64_tr_b16 v[156:157], v215 offset:16384
    v_mfma_f32_16x16x32_bf16 v[136:139], v[188:191], v[92:95], v[136:139]
    ds_read_b64_tr_b16 v[158:159], v215 offset:20480
    v_mfma_f32_16x16x32_bf16 v[132:135], v[192:195], v[64:67], v[240:243]
    s_setprio 1
    ds_read_b64_tr_b16 v[168:169], v216 offset:16384
    v_mfma_f32_16x16x32_bf16 v[140:143], v[192:195], v[68:71], v[244:247]
    ds_read_b64_tr_b16 v[170:171], v216 offset:20480
    v_mfma_f32_16x16x32_bf16 v[132:135], v[196:199], v[72:75], v[132:135]
    ds_read_b64_tr_b16 v[172:173], v217 offset:16384
    v_mfma_f32_16x16x32_bf16 v[140:143], v[196:199], v[76:79], v[140:143]
    ds_read_b64_tr_b16 v[174:175], v217 offset:20480
    v_mfma_f32_16x16x32_bf16 v[132:135], v[200:203], v[80:83], v[132:135]
    ds_read_b64_tr_b16 v[176:177], v218 offset:16384
    v_mfma_f32_16x16x32_bf16 v[140:143], v[200:203], v[84:87], v[140:143]
    ds_read_b64_tr_b16 v[178:179], v218 offset:20480
    v_mfma_f32_16x16x32_bf16 v[132:135], v[204:207], v[88:91], v[132:135]
    ds_read_b64_tr_b16 v[180:181], v219 offset:16384
    v_mfma_f32_16x16x32_bf16 v[140:143], v[204:207], v[92:95], v[140:143]
    ds_read_b64_tr_b16 v[182:183], v219 offset:20480
    v_mfma_f32_16x16x32_bf16 v[226:229], v[248:251], v[160:163], v[226:229]
    v_mfma_f32_16x16x32_bf16 v[252:255], v[248:251], v[164:167], v[252:255]
    s_waitcnt lgkmcnt(14)
    v_mfma_f32_16x16x32_bf16 v[0:3], v[144:147], v[160:163], v[0:3]
    v_mfma_f32_16x16x32_bf16 v[4:7], v[144:147], v[164:167], v[4:7]
    s_waitcnt lgkmcnt(12)
    v_mfma_f32_16x16x32_bf16 v[8:11], v[148:151], v[160:163], v[8:11]
    v_mfma_f32_16x16x32_bf16 v[12:15], v[148:151], v[164:167], v[12:15]
    ds_read_b128 v[184:187], v210 offset:32768
    s_waitcnt lgkmcnt(11)
    v_mfma_f32_16x16x32_bf16 v[16:19], v[152:155], v[160:163], v[16:19]
    v_mfma_f32_16x16x32_bf16 v[20:23], v[152:155], v[164:167], v[20:23]
    ds_read_b128 v[188:191], v211 offset:32768
    s_waitcnt lgkmcnt(10)
    v_mfma_f32_16x16x32_bf16 v[24:27], v[156:159], v[160:163], v[24:27]
    v_mfma_f32_16x16x32_bf16 v[28:31], v[156:159], v[164:167], v[28:31]
    ds_read_b128 v[192:195], v208 offset:36864
    s_waitcnt lgkmcnt(9)
    v_mfma_f32_16x16x32_bf16 v[32:35], v[168:171], v[160:163], v[32:35]
    v_mfma_f32_16x16x32_bf16 v[36:39], v[168:171], v[164:167], v[36:39]
    ds_read_b128 v[196:199], v209 offset:36864
    s_waitcnt lgkmcnt(8)
    v_mfma_f32_16x16x32_bf16 v[40:43], v[172:175], v[160:163], v[40:43]
    v_mfma_f32_16x16x32_bf16 v[44:47], v[172:175], v[164:167], v[44:47]
    ds_read_b128 v[200:203], v210 offset:36864
    s_waitcnt lgkmcnt(7)
    v_mfma_f32_16x16x32_bf16 v[48:51], v[176:179], v[160:163], v[48:51]
    v_mfma_f32_16x16x32_bf16 v[52:55], v[176:179], v[164:167], v[52:55]
    ds_read_b128 v[204:207], v211 offset:36864
    s_waitcnt lgkmcnt(6)
    v_mfma_f32_16x16x32_bf16 v[56:59], v[180:183], v[160:163], v[56:59]
    v_mfma_f32_16x16x32_bf16 v[60:63], v[180:183], v[164:167], v[60:63]
    s_setprio 3
    s_cbranch_vccz L_g31
    s_waitcnt vmcnt(8)
    s_barrier
L_g31:
    v_exp_f32 v128, v128
    v_exp_f32 v129, v129
    v_exp_f32 v130, v130
    v_exp_f32 v131, v131
    v_exp_f32 v132, v132
    s_add_u32 m0, s35, 139264
    s_add_u32 s34, s48, 139264
    buffer_load_dwordx4 v221, s[20:23], s34 offen nt lds
    v_exp_f32 v133, v133
    v_cvt_pk_bf16_f32 v160, v128, v129
    v_cvt_pk_bf16_f32 v161, v130, v131
    v_exp_f32 v134, v134
    v_exp_f32 v135, v135
    ds_read_b128 v[176:179], v208 offset:32768
    v_exp_f32 v136, v136
    v_exp_f32 v137, v137
    v_cvt_pk_bf16_f32 v162, v132, v133
    v_cvt_pk_bf16_f32 v163, v134, v135
    v_exp_f32 v138, v138
    s_add_u32 m0, s49, 73728
    s_add_u32 s34, s48, 155648
    buffer_load_dwordx4 v220, s[16:19], s34 offen nt lds
    v_exp_f32 v139, v139
    v_exp_f32 v140, v140
    v_exp_f32 v141, v141
    v_cvt_pk_bf16_f32 v164, v136, v137
    v_cvt_pk_bf16_f32 v165, v138, v139
    ds_read_b128 v[180:183], v209 offset:32768
    v_exp_f32 v142, v142
    v_exp_f32 v143, v143
    v_cvt_pk_bf16_f32 v166, v140, v141
    v_cvt_pk_bf16_f32 v167, v142, v143
    s_waitcnt vmcnt(9)
    v_lshlrev_b32 v234, 16, v112
    v_and_b32 v235, 0xffff0000, v112
    v_mul_f32 v234, s32, v234
    v_mul_f32 v235, s32, v235
    v_lshlrev_b32 v236, 16, v113
    v_and_b32 v237, 0xffff0000, v113
    v_mul_f32 v236, s32, v236
    v_mul_f32 v237, s32, v237
    v_cvt_pk_bf16_f32 v112, v234, v235
    v_lshlrev_b32 v234, 16, v114
    v_and_b32 v235, 0xffff0000, v114
    v_mul_f32 v234, s32, v234
    v_mul_f32 v235, s32, v235
    v_cvt_pk_bf16_f32 v113, v236, v237
    v_lshlrev_b32 v236, 16, v115
    v_and_b32 v237, 0xffff0000, v115
    v_mul_f32 v236, s32, v236
    v_mul_f32 v237, s32, v237
    v_cvt_pk_bf16_f32 v114, v234, v235
    v_cvt_pk_bf16_f32 v115, v236, v237
    s_waitcnt vmcnt(8)
    v_lshlrev_b32 v234, 16, v120
    v_and_b32 v235, 0xffff0000, v120
    v_mul_f32 v234, s32, v234
    v_mul_f32 v235, s32, v235
    v_lshlrev_b32 v236, 16, v121
    v_and_b32 v237, 0xffff0000, v121
    v_mul_f32 v236, s32, v236
    v_mul_f32 v237, s32, v237
    v_cvt_pk_bf16_f32 v120, v234, v235
    v_lshlrev_b32 v234, 16, v122
    v_and_b32 v235, 0xffff0000, v122
    v_mul_f32 v234, s32, v234
    v_mul_f32 v235, s32, v235
    v_cvt_pk_bf16_f32 v121, v236, v237
    v_lshlrev_b32 v236, 16, v123
    v_and_b32 v237, 0xffff0000, v123
    v_mul_f32 v236, s32, v236
    v_mul_f32 v237, s32, v237
    v_cvt_pk_bf16_f32 v122, v234, v235
    v_cvt_pk_bf16_f32 v123, v236, v237
    v_add_u32 v208, 40960, v208
    v_add_u32 v209, 40960, v209
    v_add_u32 v210, 40960, v210
    v_add_u32 v211, 40960, v211
    s_cbranch_vccnz L_g32
    s_barrier
L_g32:
    s_waitcnt lgkmcnt(0)
    s_setprio 0
    v_mfma_f32_16x16x32_bf16 v[128:131], v[176:179], v[64:67], v[240:243]
    ds_read_b64_tr_b16 v[144:145], v212 offset:24576
    v_mfma_f32_16x16x32_bf16 v[136:139], v[176:179], v[68:71], v[244:247]
    ds_read_b64_tr_b16 v[146:147], v212 offset:28672
    v_mfma_f32_16x16x32_bf16 v[128:131], v[180:183], v[72:75], v[128:131]
    ds_read_b64_tr_b16 v[148:149], v213 offset:24576
    v_mfma_f32_16x16x32_bf16 v[136:139], v[180:183], v[76:79], v[136:139]
    ds_read_b64_tr_b16 v[150:151], v213 offset:28672
    v_mfma_f32_16x16x32_bf16 v[128:131], v[184:187], v[80:83], v[128:131]
    ds_read_b64_tr_b16 v[152:153], v214 offset:24576
    v_mfma_f32_16x16x32_bf16 v[136:139], v[184:187], v[84:87], v[136:139]
    ds_read_b64_tr_b16 v[154:155], v214 offset:28672
    v_mfma_f32_16x16x32_bf16 v[128:131], v[188:191], v[88:91], v[128:131]
    ds_read_b64_tr_b16 v[156:157], v215 offset:24576
    v_mfma_f32_16x16x32_bf16 v[136:139], v[188:191], v[92:95], v[136:139]
    ds_read_b64_tr_b16 v[158:159], v215 offset:28672
    v_mfma_f32_16x16x32_bf16 v[132:135], v[192:195], v[64:67], v[240:243]
    s_setprio 1
    ds_read_b64_tr_b16 v[168:169], v216 offset:24576
    v_mfma_f32_16x16x32_bf16 v[140:143], v[192:195], v[68:71], v[244:247]
    ds_read_b64_tr_b16 v[170:171], v216 offset:28672
    v_mfma_f32_16x16x32_bf16 v[132:135], v[196:199], v[72:75], v[132:135]
    ds_read_b64_tr_b16 v[172:173], v217 offset:24576
    v_mfma_f32_16x16x32_bf16 v[140:143], v[196:199], v[76:79], v[140:143]
    ds_read_b64_tr_b16 v[174:175], v217 offset:28672
    v_mfma_f32_16x16x32_bf16 v[132:135], v[200:203], v[80:83], v[132:135]
    ds_read_b64_tr_b16 v[176:177], v218 offset:24576
    v_mfma_f32_16x16x32_bf16 v[140:143], v[200:203], v[84:87], v[140:143]
    ds_read_b64_tr_b16 v[178:179], v218 offset:28672
    v_mfma_f32_16x16x32_bf16 v[132:135], v[204:207], v[88:91], v[132:135]
    ds_read_b64_tr_b16 v[180:181], v219 offset:24576
    v_mfma_f32_16x16x32_bf16 v[140:143], v[204:207], v[92:95], v[140:143]
    ds_read_b64_tr_b16 v[182:183], v219 offset:28672
    v_mfma_f32_16x16x32_bf16 v[226:229], v[248:251], v[160:163], v[226:229]
    v_mfma_f32_16x16x32_bf16 v[252:255], v[248:251], v[164:167], v[252:255]
    s_waitcnt lgkmcnt(14)
    v_mfma_f32_16x16x32_bf16 v[0:3], v[144:147], v[160:163], v[0:3]
    v_mfma_f32_16x16x32_bf16 v[4:7], v[144:147], v[164:167], v[4:7]
    s_waitcnt lgkmcnt(12)
    v_mfma_f32_16x16x32_bf16 v[8:11], v[148:151], v[160:163], v[8:11]
    v_mfma_f32_16x16x32_bf16 v[12:15], v[148:151], v[164:167], v[12:15]
    ds_read_b128 v[184:187], v210 offset:0
    s_waitcnt lgkmcnt(11)
    v_mfma_f32_16x16x32_bf16 v[16:19], v[152:155], v[160:163], v[16:19]
    v_mfma_f32_16x16x32_bf16 v[20:23], v[152:155], v[164:167], v[20:23]
    ds_read_b128 v[188:191], v211 offset:0
    s_waitcnt lgkmcnt(10)
    v_mfma_f32_16x16x32_bf16 v[24:27], v[156:159], v[160:163], v[24:27]
    v_mfma_f32_16x16x32_bf16 v[28:31], v[156:159], v[164:167], v[28:31]
    ds_read_b128 v[192:195], v208 offset:4096
    s_waitcnt lgkmcnt(9)
    v_mfma_f32_16x16x32_bf16 v[32:35], v[168:171], v[160:163], v[32:35]
    v_mfma_f32_16x16x32_bf16 v[36:39], v[168:171], v[164:167], v[36:39]
    ds_read_b128 v[196:199], v209 offset:4096
    s_waitcnt lgkmcnt(8)
    v_mfma_f32_16x16x32_bf16 v[40:43], v[172:175], v[160:163], v[40:43]
    v_mfma_f32_16x16x32_bf16 v[44:47], v[172:175], v[164:167], v[44:47]
    ds_read_b128 v[200:203], v210 offset:4096
    s_waitcnt lgkmcnt(7)
    v_mfma_f32_16x16x32_bf16 v[48:51], v[176:179], v[160:163], v[48:51]
    v_mfma_f32_16x16x32_bf16 v[52:55], v[176:179], v[164:167], v[52:55]
    ds_read_b128 v[204:207], v211 offset:4096
    s_waitcnt lgkmcnt(6)
    v_mfma_f32_16x16x32_bf16 v[56:59], v[180:183], v[160:163], v[56:59]
    v_mfma_f32_16x16x32_bf16 v[60:63], v[180:183], v[164:167], v[60:63]
    s_setprio 3
    v_exp_f32 v128, v128
    v_exp_f32 v129, v129
    v_exp_f32 v130, v130
    v_exp_f32 v131, v131
    v_exp_f32 v132, v132
    s_add_u32 m0, s49, 147456
    s_add_u32 s34, s48, 147456
    buffer_load_dwordx4 v221, s[20:23], s34 offen nt lds
    v_exp_f32 v133, v133
    v_cvt_pk_bf16_f32 v160, v128, v129
    v_cvt_pk_bf16_f32 v161, v130, v131
    v_exp_f32 v134, v134
    v_exp_f32 v135, v135
    ds_read_b128 v[176:179], v208 offset:0
    v_exp_f32 v136, v136
    v_exp_f32 v137, v137
    v_cvt_pk_bf16_f32 v162, v132, v133
    v_cvt_pk_bf16_f32 v163, v134, v135
    v_exp_f32 v138, v138
    s_add_u32 m0, s35, 0
    s_add_u32 s34, s48, 163840
    buffer_load_dwordx4 v220, s[16:19], s34 offen nt lds
    v_exp_f32 v139, v139
    v_exp_f32 v140, v140
    v_exp_f32 v141, v141
    v_cvt_pk_bf16_f32 v164, v136, v137
    v_cvt_pk_bf16_f32 v165, v138, v139
    ds_read_b128 v[180:183], v209 offset:0
    v_exp_f32 v142, v142
    v_exp_f32 v143, v143
    v_cvt_pk_bf16_f32 v166, v140, v141
    v_cvt_pk_bf16_f32 v167, v142, v143
    s_waitcnt vmcnt(7)
    v_lshlrev_b32 v234, 16, v116
    v_and_b32 v235, 0xffff0000, v116
    v_mul_f32 v234, s32, v234
    v_mul_f32 v235, s32, v235
    v_lshlrev_b32 v236, 16, v117
    v_and_b32 v237, 0xffff0000, v117
    v_mul_f32 v236, s32, v236
    v_mul_f32 v237, s32, v237
    v_cvt_pk_bf16_f32 v116, v234, v235
    v_lshlrev_b32 v234, 16, v118
    v_and_b32 v235, 0xffff0000, v118
    v_mul_f32 v234, s32, v234
    v_mul_f32 v235, s32, v235
    v_cvt_pk_bf16_f32 v117, v236, v237
    v_lshlrev_b32 v236, 16, v119
    v_and_b32 v237, 0xffff0000, v119
    v_mul_f32 v236, s32, v236
    v_mul_f32 v237, s32, v237
    v_cvt_pk_bf16_f32 v118, v234, v235
    v_cvt_pk_bf16_f32 v119, v236, v237
    s_waitcnt lgkmcnt(0)
    s_setprio 0
    v_mfma_f32_16x16x32_bf16 v[128:131], v[176:179], v[64:67], v[240:243]
    ds_read_b64_tr_b16 v[144:145], v212 offset:32768
    v_mfma_f32_16x16x32_bf16 v[136:139], v[176:179], v[68:71], v[244:247]
    ds_read_b64_tr_b16 v[146:147], v212 offset:36864
    v_mfma_f32_16x16x32_bf16 v[128:131], v[180:183], v[72:75], v[128:131]
    ds_read_b64_tr_b16 v[148:149], v213 offset:32768
    v_mfma_f32_16x16x32_bf16 v[136:139], v[180:183], v[76:79], v[136:139]
    ds_read_b64_tr_b16 v[150:151], v213 offset:36864
    v_mfma_f32_16x16x32_bf16 v[128:131], v[184:187], v[80:83], v[128:131]
    ds_read_b64_tr_b16 v[152:153], v214 offset:32768
    v_mfma_f32_16x16x32_bf16 v[136:139], v[184:187], v[84:87], v[136:139]
    ds_read_b64_tr_b16 v[154:155], v214 offset:36864
    v_mfma_f32_16x16x32_bf16 v[128:131], v[188:191], v[88:91], v[128:131]
    ds_read_b64_tr_b16 v[156:157], v215 offset:32768
    v_mfma_f32_16x16x32_bf16 v[136:139], v[188:191], v[92:95], v[136:139]
    ds_read_b64_tr_b16 v[158:159], v215 offset:36864
    v_mfma_f32_16x16x32_bf16 v[132:135], v[192:195], v[64:67], v[240:243]
    s_setprio 1
    ds_read_b64_tr_b16 v[168:169], v216 offset:32768
    v_mfma_f32_16x16x32_bf16 v[140:143], v[192:195], v[68:71], v[244:247]
    ds_read_b64_tr_b16 v[170:171], v216 offset:36864
    v_mfma_f32_16x16x32_bf16 v[132:135], v[196:199], v[72:75], v[132:135]
    ds_read_b64_tr_b16 v[172:173], v217 offset:32768
    v_mfma_f32_16x16x32_bf16 v[140:143], v[196:199], v[76:79], v[140:143]
    ds_read_b64_tr_b16 v[174:175], v217 offset:36864
    v_mfma_f32_16x16x32_bf16 v[132:135], v[200:203], v[80:83], v[132:135]
    ds_read_b64_tr_b16 v[176:177], v218 offset:32768
    v_mfma_f32_16x16x32_bf16 v[140:143], v[200:203], v[84:87], v[140:143]
    ds_read_b64_tr_b16 v[178:179], v218 offset:36864
    v_mfma_f32_16x16x32_bf16 v[132:135], v[204:207], v[88:91], v[132:135]
    ds_read_b64_tr_b16 v[180:181], v219 offset:32768
    v_mfma_f32_16x16x32_bf16 v[140:143], v[204:207], v[92:95], v[140:143]
    ds_read_b64_tr_b16 v[182:183], v219 offset:36864
    v_mfma_f32_16x16x32_bf16 v[226:229], v[248:251], v[160:163], v[226:229]
    v_mfma_f32_16x16x32_bf16 v[252:255], v[248:251], v[164:167], v[252:255]
    s_waitcnt lgkmcnt(14)
    v_mfma_f32_16x16x32_bf16 v[0:3], v[144:147], v[160:163], v[0:3]
    v_mfma_f32_16x16x32_bf16 v[4:7], v[144:147], v[164:167], v[4:7]
    s_waitcnt lgkmcnt(12)
    v_mfma_f32_16x16x32_bf16 v[8:11], v[148:151], v[160:163], v[8:11]
    v_mfma_f32_16x16x32_bf16 v[12:15], v[148:151], v[164:167], v[12:15]
    ds_read_b128 v[184:187], v210 offset:8192
    s_waitcnt lgkmcnt(11)
    v_mfma_f32_16x16x32_bf16 v[16:19], v[152:155], v[160:163], v[16:19]
    v_mfma_f32_16x16x32_bf16 v[20:23], v[152:155], v[164:167], v[20:23]
    ds_read_b128 v[188:191], v211 offset:8192
    s_waitcnt lgkmcnt(10)
    v_mfma_f32_16x16x32_bf16 v[24:27], v[156:159], v[160:163], v[24:27]
    v_mfma_f32_16x16x32_bf16 v[28:31], v[156:159], v[164:167], v[28:31]
    ds_read_b128 v[192:195], v208 offset:12288
    s_waitcnt lgkmcnt(9)
    v_mfma_f32_16x16x32_bf16 v[32:35], v[168:171], v[160:163], v[32:35]
    v_mfma_f32_16x16x32_bf16 v[36:39], v[168:171], v[164:167], v[36:39]
    ds_read_b128 v[196:199], v209 offset:12288
    s_waitcnt lgkmcnt(8)
    v_mfma_f32_16x16x32_bf16 v[40:43], v[172:175], v[160:163], v[40:43]
    v_mfma_f32_16x16x32_bf16 v[44:47], v[172:175], v[164:167], v[44:47]
    ds_read_b128 v[200:203], v210 offset:12288
    s_waitcnt lgkmcnt(7)
    v_mfma_f32_16x16x32_bf16 v[48:51], v[176:179], v[160:163], v[48:51]
    v_mfma_f32_16x16x32_bf16 v[52:55], v[176:179], v[164:167], v[52:55]
    ds_read_b128 v[204:207], v211 offset:12288
    s_waitcnt lgkmcnt(6)
    v_mfma_f32_16x16x32_bf16 v[56:59], v[180:183], v[160:163], v[56:59]
    v_mfma_f32_16x16x32_bf16 v[60:63], v[180:183], v[164:167], v[60:63]
    s_setprio 3
    s_cbranch_vccz L_g33
    s_waitcnt vmcnt(4)
    s_barrier
L_g33:
    v_add_u32 v212, 40960, v212
    v_add_u32 v213, 40960, v213
    v_add_u32 v214, 40960, v214
    v_add_u32 v215, 40960, v215
    v_add_u32 v216, 40960, v216
    v_add_u32 v217, 40960, v217
    v_add_u32 v218, 40960, v218
    v_add_u32 v219, 40960, v219
    v_exp_f32 v128, v128
    v_exp_f32 v129, v129
    v_exp_f32 v130, v130
    v_exp_f32 v131, v131
    v_exp_f32 v132, v132
    s_add_u32 m0, s49, 155648
    s_add_u32 s34, s48, 155648
    buffer_load_dwordx4 v221, s[20:23], s34 offen nt lds
    v_exp_f32 v133, v133
    v_cvt_pk_bf16_f32 v160, v128, v129
    v_cvt_pk_bf16_f32 v161, v130, v131
    v_exp_f32 v134, v134
    v_exp_f32 v135, v135
    ds_read_b128 v[176:179], v208 offset:8192
    v_exp_f32 v136, v136
    v_exp_f32 v137, v137
    v_cvt_pk_bf16_f32 v162, v132, v133
    v_cvt_pk_bf16_f32 v163, v134, v135
    v_exp_f32 v138, v138
    s_add_u32 m0, s35, 8192
    s_add_u32 s34, s48, 172032
    buffer_load_dwordx4 v220, s[16:19], s34 offen nt lds
    v_exp_f32 v139, v139
    v_exp_f32 v140, v140
    v_exp_f32 v141, v141
    v_cvt_pk_bf16_f32 v164, v136, v137
    v_cvt_pk_bf16_f32 v165, v138, v139
    ds_read_b128 v[180:183], v209 offset:8192
    v_exp_f32 v142, v142
    v_exp_f32 v143, v143
    v_cvt_pk_bf16_f32 v166, v140, v141
    v_cvt_pk_bf16_f32 v167, v142, v143
    s_waitcnt vmcnt(8)
    v_lshlrev_b32 v234, 16, v124
    v_and_b32 v235, 0xffff0000, v124
    v_mul_f32 v234, s32, v234
    v_mul_f32 v235, s32, v235
    v_lshlrev_b32 v236, 16, v125
    v_and_b32 v237, 0xffff0000, v125
    v_mul_f32 v236, s32, v236
    v_mul_f32 v237, s32, v237
    v_cvt_pk_bf16_f32 v124, v234, v235
    v_lshlrev_b32 v234, 16, v126
    v_and_b32 v235, 0xffff0000, v126
    v_mul_f32 v234, s32, v234
    v_mul_f32 v235, s32, v235
    v_cvt_pk_bf16_f32 v125, v236, v237
    v_lshlrev_b32 v236, 16, v127
    v_and_b32 v237, 0xffff0000, v127
    v_mul_f32 v236, s32, v236
    v_mul_f32 v237, s32, v237
    v_cvt_pk_bf16_f32 v126, v234, v235
    v_cvt_pk_bf16_f32 v127, v236, v237
    s_cbranch_vccnz L_g34
    s_waitcnt vmcnt(6)
    s_barrier
L_g34:
    s_waitcnt lgkmcnt(0)
    s_setprio 0
    v_mfma_f32_16x16x32_bf16 v[128:131], v[176:179], v[96:99], 0
    ds_read_b64_tr_b16 v[144:145], v212 offset:0
    v_mfma_f32_16x16x32_bf16 v[136:139], v[176:179], v[100:103], 0
    ds_read_b64_tr_b16 v[146:147], v212 offset:4096
    v_mfma_f32_16x16x32_bf16 v[128:131], v[180:183], v[104:107], v[128:131]
    ds_read_b64_tr_b16 v[148:149], v213 offset:0
    v_mfma_f32_16x16x32_bf16 v[136:139], v[180:183], v[108:111], v[136:139]
    ds_read_b64_tr_b16 v[150:151], v213 offset:4096
    v_mfma_f32_16x16x32_bf16 v[128:131], v[184:187], v[112:115], v[128:131]
    ds_read_b64_tr_b16 v[152:153], v214 offset:0
    v_mfma_f32_16x16x32_bf16 v[136:139], v[184:187], v[116:119], v[136:139]
    ds_read_b64_tr_b16 v[154:155], v214 offset:4096
    v_mfma_f32_16x16x32_bf16 v[128:131], v[188:191], v[120:123], v[128:131]
    ds_read_b64_tr_b16 v[156:157], v215 offset:0
    v_mfma_f32_16x16x32_bf16 v[136:139], v[188:191], v[124:127], v[136:139]
    ds_read_b64_tr_b16 v[158:159], v215 offset:4096
    v_mfma_f32_16x16x32_bf16 v[132:135], v[192:195], v[96:99], 0
    s_setprio 1
    ds_read_b64_tr_b16 v[168:169], v216 offset:0
    v_mfma_f32_16x16x32_bf16 v[140:143], v[192:195], v[100:103], 0
    ds_read_b64_tr_b16 v[170:171], v216 offset:4096
    v_mfma_f32_16x16x32_bf16 v[132:135], v[196:199], v[104:107], v[132:135]
    ds_read_b64_tr_b16 v[172:173], v217 offset:0
    v_mfma_f32_16x16x32_bf16 v[140:143], v[196:199], v[108:111], v[140:143]
    ds_read_b64_tr_b16 v[174:175], v217 offset:4096
    v_mfma_f32_16x16x32_bf16 v[132:135], v[200:203], v[112:115], v[132:135]
    ds_read_b64_tr_b16 v[176:177], v218 offset:0
    v_mfma_f32_16x16x32_bf16 v[140:143], v[200:203], v[116:119], v[140:143]
    ds_read_b64_tr_b16 v[178:179], v218 offset:4096
    v_mfma_f32_16x16x32_bf16 v[132:135], v[204:207], v[120:123], v[132:135]
    ds_read_b64_tr_b16 v[180:181], v219 offset:0
    v_mfma_f32_16x16x32_bf16 v[140:143], v[204:207], v[124:127], v[140:143]
    ds_read_b64_tr_b16 v[182:183], v219 offset:4096
    v_mfma_f32_16x16x32_bf16 v[226:229], v[248:251], v[160:163], v[226:229]
    v_mfma_f32_16x16x32_bf16 v[252:255], v[248:251], v[164:167], v[252:255]
    s_waitcnt lgkmcnt(14)
    v_mfma_f32_16x16x32_bf16 v[0:3], v[144:147], v[160:163], v[0:3]
    v_mfma_f32_16x16x32_bf16 v[4:7], v[144:147], v[164:167], v[4:7]
    s_waitcnt lgkmcnt(12)
    v_mfma_f32_16x16x32_bf16 v[8:11], v[148:151], v[160:163], v[8:11]
    v_mfma_f32_16x16x32_bf16 v[12:15], v[148:151], v[164:167], v[12:15]
    ds_read_b128 v[184:187], v210 offset:16384
    s_waitcnt lgkmcnt(11)
    v_mfma_f32_16x16x32_bf16 v[16:19], v[152:155], v[160:163], v[16:19]
    v_mfma_f32_16x16x32_bf16 v[20:23], v[152:155], v[164:167], v[20:23]
    ds_read_b128 v[188:191], v211 offset:16384
    s_waitcnt lgkmcnt(10)
    v_mfma_f32_16x16x32_bf16 v[24:27], v[156:159], v[160:163], v[24:27]
    v_mfma_f32_16x16x32_bf16 v[28:31], v[156:159], v[164:167], v[28:31]
    ds_read_b128 v[192:195], v208 offset:20480
    s_waitcnt lgkmcnt(9)
    v_mfma_f32_16x16x32_bf16 v[32:35], v[168:171], v[160:163], v[32:35]
    v_mfma_f32_16x16x32_bf16 v[36:39], v[168:171], v[164:167], v[36:39]
    ds_read_b128 v[196:199], v209 offset:20480
    s_waitcnt lgkmcnt(8)
    v_mfma_f32_16x16x32_bf16 v[40:43], v[172:175], v[160:163], v[40:43]
    v_mfma_f32_16x16x32_bf16 v[44:47], v[172:175], v[164:167], v[44:47]
    ds_read_b128 v[200:203], v210 offset:20480
    s_waitcnt lgkmcnt(7)
    v_mfma_f32_16x16x32_bf16 v[48:51], v[176:179], v[160:163], v[48:51]
    v_mfma_f32_16x16x32_bf16 v[52:55], v[176:179], v[164:167], v[52:55]
    ds_read_b128 v[204:207], v211 offset:20480
    s_waitcnt lgkmcnt(6)
    v_mfma_f32_16x16x32_bf16 v[56:59], v[180:183], v[160:163], v[56:59]
    v_mfma_f32_16x16x32_bf16 v[60:63], v[180:183], v[164:167], v[60:63]
    s_setprio 3
    v_max3_f32 v160, v128, v129, v130
    v_max3_f32 v161, v136, v137, v138
    v_max3_f32 v160, v160, v131, v132
    v_max3_f32 v161, v161, v139, v140
    v_max3_f32 v160, v160, v133, v134
    v_max3_f32 v161, v161, v141, v142
    v_max_f32 v160, v160, v135
    v_max_f32 v161, v161, v143
    v_mov_b32 v162, v160
    v_mov_b32 v163, v161
    s_nop 0
    v_permlane16_swap_b32 v160, v162
    v_permlane16_swap_b32 v161, v163
    v_max_f32 v160, v160, v162
    v_max_f32 v161, v161, v163
    v_mov_b32 v162, v160
    v_mov_b32 v163, v161
    s_nop 0
    v_permlane32_swap_b32 v160, v162
    v_permlane32_swap_b32 v161, v163
    v_max_f32 v160, v160, v162
    v_max_f32 v161, v161, v163
    v_sub_f32 v240, 0, v160
    v_sub_f32 v244, 0, v161
    v_sub_f32 v241, 0, v160
    v_sub_f32 v245, 0, v161
    v_sub_f32 v242, 0, v160
    v_sub_f32 v246, 0, v161
    v_sub_f32 v243, 0, v160
    v_sub_f32 v247, 0, v161
    v_add_f32 v128, v128, v240
    v_add_f32 v129, v129, v240
    v_exp_f32 v128, v128
    v_add_f32 v130, v130, v240
    v_add_f32 v131, v131, v240
    v_exp_f32 v129, v129
    v_exp_f32 v130, v130
    v_add_f32 v132, v132, v240
    v_add_f32 v133, v133, v240
    v_exp_f32 v131, v131
    s_add_u32 m0, s35, 81920
    s_add_u32 s34, s48, 163840
    buffer_load_dwordx4 v221, s[20:23], s34 offen nt lds
    v_exp_f32 v132, v132
    v_add_f32 v134, v134, v240
    v_add_f32 v135, v135, v240
    v_exp_f32 v133, v133
    v_cvt_pk_bf16_f32 v160, v128, v129
    v_cvt_pk_bf16_f32 v161, v130, v131
    v_exp_f32 v134, v134
    v_add_f32 v136, v136, v244
    v_add_f32 v137, v137, v244
    ds_read_b128 v[176:179], v208 offset:16384
    v_exp_f32 v135, v135
    v_exp_f32 v136, v136
    v_add_f32 v138, v138, v244
    v_add_f32 v139, v139, v244
    v_exp_f32 v137, v137
    v_cvt_pk_bf16_f32 v162, v132, v133
    v_cvt_pk_bf16_f32 v163, v134, v135
    v_exp_f32 v138, v138
    s_add_u32 m0, s35, 16384
    s_add_u32 s34, s48, 180224
    buffer_load_dwordx4 v220, s[16:19], s34 offen nt lds
    v_add_f32 v140, v140, v244
    v_add_f32 v141, v141, v244
    v_exp_f32 v139, v139
    v_exp_f32 v140, v140
    v_add_f32 v142, v142, v244
    v_add_f32 v143, v143, v244
    v_exp_f32 v141, v141
    v_cvt_pk_bf16_f32 v164, v136, v137
    v_cvt_pk_bf16_f32 v165, v138, v139
    ds_read_b128 v[180:183], v209 offset:16384
    v_exp_f32 v142, v142
    v_exp_f32 v143, v143
    v_cvt_pk_bf16_f32 v166, v140, v141
    v_cvt_pk_bf16_f32 v167, v142, v143
    v_rcp_f32 v230, v226
    v_rcp_f32 v232, v252
    v_mov_b32 v231, 0x4e800000
    v_add_f32 v233, v226, v252
    v_add_f32 v233, v233, v230
    v_add_f32 v233, v233, v232
    v_cmp_nlt_f32 s[36:37], v233, v231
    v_mul_f32 v0, v0, v230
    v_mul_f32 v1, v1, v230
    v_mul_f32 v2, v2, v230
    v_mul_f32 v3, v3, v230
    v_cvt_pk_bf16_f32 v64, v0, v1
    v_mul_f32 v4, v4, v232
    v_mul_f32 v5, v5, v232
    v_cvt_pk_bf16_f32 v65, v2, v3
    v_mul_f32 v6, v6, v232
    v_mul_f32 v7, v7, v232
    v_cvt_pk_bf16_f32 v68, v4, v5
    v_mul_f32 v8, v8, v230
    v_mul_f32 v9, v9, v230
    v_cvt_pk_bf16_f32 v69, v6, v7
    v_mul_f32 v10, v10, v230
    v_mul_f32 v11, v11, v230
    v_cvt_pk_bf16_f32 v66, v8, v9
    v_mul_f32 v12, v12, v232
    v_mul_f32 v13, v13, v232
    v_cvt_pk_bf16_f32 v67, v10, v11
    v_mul_f32 v14, v14, v232
    v_mul_f32 v15, v15, v232
    v_cvt_pk_bf16_f32 v70, v12, v13
    v_cvt_pk_bf16_f32 v71, v14, v15
    v_mul_f32 v16, v16, v230
    v_mul_f32 v17, v17, v230
    v_mul_f32 v18, v18, v230
    v_mul_f32 v19, v19, v230
    v_cvt_pk_bf16_f32 v72, v16, v17
    v_mul_f32 v20, v20, v232
    v_mul_f32 v21, v21, v232
    v_cvt_pk_bf16_f32 v73, v18, v19
    v_mul_f32 v22, v22, v232
    v_mul_f32 v23, v23, v232
    v_cvt_pk_bf16_f32 v76, v20, v21
    v_mul_f32 v24, v24, v230
    v_mul_f32 v25, v25, v230
    v_cvt_pk_bf16_f32 v77, v22, v23
    v_mul_f32 v26, v26, v230
    v_mul_f32 v27, v27, v230
    v_cvt_pk_bf16_f32 v74, v24, v25
    v_mul_f32 v28, v28, v232
    v_mul_f32 v29, v29, v232
    v_cvt_pk_bf16_f32 v75, v26, v27
    v_mul_f32 v30, v30, v232
    v_mul_f32 v31, v31, v232
    v_cvt_pk_bf16_f32 v78, v28, v29
    v_cvt_pk_bf16_f32 v79, v30, v31
    v_mul_f32 v32, v32, v230
    v_mul_f32 v33, v33, v230
    v_mul_f32 v34, v34, v230
    v_mul_f32 v35, v35, v230
    v_cvt_pk_bf16_f32 v80, v32, v33
    v_mul_f32 v36, v36, v232
    v_mul_f32 v37, v37, v232
    v_cvt_pk_bf16_f32 v81, v34, v35
    v_mul_f32 v38, v38, v232
    v_mul_f32 v39, v39, v232
    v_cvt_pk_bf16_f32 v84, v36, v37
    v_mul_f32 v40, v40, v230
    v_mul_f32 v41, v41, v230
    v_cvt_pk_bf16_f32 v85, v38, v39
    v_mul_f32 v42, v42, v230
    v_mul_f32 v43, v43, v230
    v_cvt_pk_bf16_f32 v82, v40, v41
    v_mul_f32 v44, v44, v232
    v_mul_f32 v45, v45, v232
    v_cvt_pk_bf16_f32 v83, v42, v43
    v_mul_f32 v46, v46, v232
    v_mul_f32 v47, v47, v232
    v_cvt_pk_bf16_f32 v86, v44, v45
    v_cvt_pk_bf16_f32 v87, v46, v47
    v_mul_f32 v48, v48, v230
    v_mul_f32 v49, v49, v230
    v_mul_f32 v50, v50, v230
    v_mul_f32 v51, v51, v230
    v_cvt_pk_bf16_f32 v88, v48, v49
    v_mul_f32 v52, v52, v232
    v_mul_f32 v53, v53, v232
    v_cvt_pk_bf16_f32 v89, v50, v51
    v_mul_f32 v54, v54, v232
    v_mul_f32 v55, v55, v232
    v_cvt_pk_bf16_f32 v92, v52, v53
    v_mul_f32 v56, v56, v230
    v_mul_f32 v57, v57, v230
    v_cvt_pk_bf16_f32 v93, v54, v55
    v_mul_f32 v58, v58, v230
    v_mul_f32 v59, v59, v230
    v_cvt_pk_bf16_f32 v90, v56, v57
    v_mul_f32 v60, v60, v232
    v_mul_f32 v61, v61, v232
    v_cvt_pk_bf16_f32 v91, v58, v59
    v_mul_f32 v62, v62, v232
    v_mul_f32 v63, v63, v232
    v_cvt_pk_bf16_f32 v94, v60, v61
    v_cvt_pk_bf16_f32 v95, v62, v63
    s_waitcnt lgkmcnt(0)
    s_setprio 0
    v_mfma_f32_16x16x32_bf16 v[128:131], v[176:179], v[96:99], v[240:243]
    ds_read_b64_tr_b16 v[144:145], v212 offset:8192
    v_mfma_f32_16x16x32_bf16 v[136:139], v[176:179], v[100:103], v[244:247]
    ds_read_b64_tr_b16 v[146:147], v212 offset:12288
    v_mfma_f32_16x16x32_bf16 v[128:131], v[180:183], v[104:107], v[128:131]
    ds_read_b64_tr_b16 v[148:149], v213 offset:8192
    v_mfma_f32_16x16x32_bf16 v[136:139], v[180:183], v[108:111], v[136:139]
    ds_read_b64_tr_b16 v[150:151], v213 offset:12288
    v_mfma_f32_16x16x32_bf16 v[128:131], v[184:187], v[112:115], v[128:131]
    ds_read_b64_tr_b16 v[152:153], v214 offset:8192
    v_mfma_f32_16x16x32_bf16 v[136:139], v[184:187], v[116:119], v[136:139]
    ds_read_b64_tr_b16 v[154:155], v214 offset:12288
    v_mfma_f32_16x16x32_bf16 v[128:131], v[188:191], v[120:123], v[128:131]
    ds_read_b64_tr_b16 v[156:157], v215 offset:8192
    v_mfma_f32_16x16x32_bf16 v[136:139], v[188:191], v[124:127], v[136:139]
    ds_read_b64_tr_b16 v[158:159], v215 offset:12288
    v_mfma_f32_16x16x32_bf16 v[132:135], v[192:195], v[96:99], v[240:243]
    s_setprio 1
    ds_read_b64_tr_b16 v[168:169], v216 offset:8192
    v_mfma_f32_16x16x32_bf16 v[140:143], v[192:195], v[100:103], v[244:247]
    ds_read_b64_tr_b16 v[170:171], v216 offset:12288
    v_mfma_f32_16x16x32_bf16 v[132:135], v[196:199], v[104:107], v[132:135]
    ds_read_b64_tr_b16 v[172:173], v217 offset:8192
    v_mfma_f32_16x16x32_bf16 v[140:143], v[196:199], v[108:111], v[140:143]
    ds_read_b64_tr_b16 v[174:175], v217 offset:12288
    v_mfma_f32_16x16x32_bf16 v[132:135], v[200:203], v[112:115], v[132:135]
    ds_read_b64_tr_b16 v[176:177], v218 offset:8192
    v_mfma_f32_16x16x32_bf16 v[140:143], v[200:203], v[116:119], v[140:143]
    ds_read_b64_tr_b16 v[178:179], v218 offset:12288
    v_mfma_f32_16x16x32_bf16 v[132:135], v[204:207], v[120:123], v[132:135]
    ds_read_b64_tr_b16 v[180:181], v219 offset:8192
    v_mfma_f32_16x16x32_bf16 v[140:143], v[204:207], v[124:127], v[140:143]
    ds_read_b64_tr_b16 v[182:183], v219 offset:12288
    v_mfma_f32_16x16x32_bf16 v[226:229], v[248:251], v[160:163], 0
    v_mfma_f32_16x16x32_bf16 v[252:255], v[248:251], v[164:167], 0
    s_waitcnt lgkmcnt(14)
    v_mfma_f32_16x16x32_bf16 v[0:3], v[144:147], v[160:163], 0
    v_mfma_f32_16x16x32_bf16 v[4:7], v[144:147], v[164:167], 0
    s_waitcnt lgkmcnt(12)
    v_mfma_f32_16x16x32_bf16 v[8:11], v[148:151], v[160:163], 0
    v_mfma_f32_16x16x32_bf16 v[12:15], v[148:151], v[164:167], 0
    ds_read_b128 v[184:187], v210 offset:24576
    s_waitcnt lgkmcnt(11)
    v_mfma_f32_16x16x32_bf16 v[16:19], v[152:155], v[160:163], 0
    v_mfma_f32_16x16x32_bf16 v[20:23], v[152:155], v[164:167], 0
    ds_read_b128 v[188:191], v211 offset:24576
    s_waitcnt lgkmcnt(10)
    v_mfma_f32_16x16x32_bf16 v[24:27], v[156:159], v[160:163], 0
    v_mfma_f32_16x16x32_bf16 v[28:31], v[156:159], v[164:167], 0
    ds_read_b128 v[192:195], v208 offset:28672
    s_waitcnt lgkmcnt(9)
    v_mfma_f32_16x16x32_bf16 v[32:35], v[168:171], v[160:163], 0
    v_mfma_f32_16x16x32_bf16 v[36:39], v[168:171], v[164:167], 0
    ds_read_b128 v[196:199], v209 offset:28672
    s_waitcnt lgkmcnt(8)
    v_mfma_f32_16x16x32_bf16 v[40:43], v[172:175], v[160:163], 0
    v_mfma_f32_16x16x32_bf16 v[44:47], v[172:175], v[164:167], 0
    ds_read_b128 v[200:203], v210 offset:28672
    s_waitcnt lgkmcnt(7)
    v_mfma_f32_16x16x32_bf16 v[48:51], v[176:179], v[160:163], 0
    v_mfma_f32_16x16x32_bf16 v[52:55], v[176:179], v[164:167], 0
    ds_read_b128 v[204:207], v211 offset:28672
    s_waitcnt lgkmcnt(6)
    v_mfma_f32_16x16x32_bf16 v[56:59], v[180:183], v[160:163], 0
    v_mfma_f32_16x16x32_bf16 v[60:63], v[180:183], v[164:167], 0
    s_setprio 3
    s_cbranch_vccz L_g35
    s_waitcnt vmcnt(4)
    s_barrier
L_g35:
    v_exp_f32 v128, v128
    v_exp_f32 v129, v129
    v_exp_f32 v130, v130
    v_exp_f32 v131, v131
    v_exp_f32 v132, v132
    s_add_u32 m0, s35, 90112
    s_add_u32 s34, s48, 172032
    buffer_load_dwordx4 v221, s[20:23], s34 offen nt lds
    v_exp_f32 v133, v133
    v_cvt_pk_bf16_f32 v160, v128, v129
    v_cvt_pk_bf16_f32 v161, v130, v131
    v_exp_f32 v134, v134
    v_exp_f32 v135, v135
    ds_read_b128 v[176:179], v208 offset:24576
    v_exp_f32 v136, v136
    v_exp_f32 v137, v137
    v_cvt_pk_bf16_f32 v162, v132, v133
    v_cvt_pk_bf16_f32 v163, v134, v135
    v_exp_f32 v138, v138
    s_add_u32 m0, s35, 24576
    s_add_u32 s34, s48, 188416
    buffer_load_dwordx4 v220, s[16:19], s34 offen nt lds
    v_exp_f32 v139, v139
    v_exp_f32 v140, v140
    v_exp_f32 v141, v141
    v_cvt_pk_bf16_f32 v164, v136, v137
    v_cvt_pk_bf16_f32 v165, v138, v139
    ds_read_b128 v[180:183], v209 offset:24576
    v_exp_f32 v142, v142
    v_exp_f32 v143, v143
    v_cvt_pk_bf16_f32 v166, v140, v141
    v_cvt_pk_bf16_f32 v167, v142, v143
    s_cbranch_vccnz L_g36
    s_waitcnt vmcnt(6)
    s_barrier
L_g36:
    s_waitcnt lgkmcnt(0)
    s_setprio 0
    v_mfma_f32_16x16x32_bf16 v[128:131], v[176:179], v[96:99], v[240:243]
    ds_read_b64_tr_b16 v[144:145], v212 offset:16384
    v_mfma_f32_16x16x32_bf16 v[136:139], v[176:179], v[100:103], v[244:247]
    ds_read_b64_tr_b16 v[146:147], v212 offset:20480
    v_mfma_f32_16x16x32_bf16 v[128:131], v[180:183], v[104:107], v[128:131]
    ds_read_b64_tr_b16 v[148:149], v213 offset:16384
    v_mfma_f32_16x16x32_bf16 v[136:139], v[180:183], v[108:111], v[136:139]
    ds_read_b64_tr_b16 v[150:151], v213 offset:20480
    v_mfma_f32_16x16x32_bf16 v[128:131], v[184:187], v[112:115], v[128:131]
    ds_read_b64_tr_b16 v[152:153], v214 offset:16384
    v_mfma_f32_16x16x32_bf16 v[136:139], v[184:187], v[116:119], v[136:139]
    ds_read_b64_tr_b16 v[154:155], v214 offset:20480
    v_mfma_f32_16x16x32_bf16 v[128:131], v[188:191], v[120:123], v[128:131]
    ds_read_b64_tr_b16 v[156:157], v215 offset:16384
    v_mfma_f32_16x16x32_bf16 v[136:139], v[188:191], v[124:127], v[136:139]
    ds_read_b64_tr_b16 v[158:159], v215 offset:20480
    v_mfma_f32_16x16x32_bf16 v[132:135], v[192:195], v[96:99], v[240:243]
    s_setprio 1
    ds_read_b64_tr_b16 v[168:169], v216 offset:16384
    v_mfma_f32_16x16x32_bf16 v[140:143], v[192:195], v[100:103], v[244:247]
    ds_read_b64_tr_b16 v[170:171], v216 offset:20480
    v_mfma_f32_16x16x32_bf16 v[132:135], v[196:199], v[104:107], v[132:135]
    ds_read_b64_tr_b16 v[172:173], v217 offset:16384
    v_mfma_f32_16x16x32_bf16 v[140:143], v[196:199], v[108:111], v[140:143]
    ds_read_b64_tr_b16 v[174:175], v217 offset:20480
    v_mfma_f32_16x16x32_bf16 v[132:135], v[200:203], v[112:115], v[132:135]
    ds_read_b64_tr_b16 v[176:177], v218 offset:16384
    v_mfma_f32_16x16x32_bf16 v[140:143], v[200:203], v[116:119], v[140:143]
    ds_read_b64_tr_b16 v[178:179], v218 offset:20480
    v_mfma_f32_16x16x32_bf16 v[132:135], v[204:207], v[120:123], v[132:135]
    ds_read_b64_tr_b16 v[180:181], v219 offset:16384
    v_mfma_f32_16x16x32_bf16 v[140:143], v[204:207], v[124:127], v[140:143]
    ds_read_b64_tr_b16 v[182:183], v219 offset:20480
    v_mfma_f32_16x16x32_bf16 v[226:229], v[248:251], v[160:163], v[226:229]
    v_mfma_f32_16x16x32_bf16 v[252:255], v[248:251], v[164:167], v[252:255]
    s_waitcnt lgkmcnt(14)
    v_mfma_f32_16x16x32_bf16 v[0:3], v[144:147], v[160:163], v[0:3]
    v_mfma_f32_16x16x32_bf16 v[4:7], v[144:147], v[164:167], v[4:7]
    s_waitcnt lgkmcnt(12)
    v_mfma_f32_16x16x32_bf16 v[8:11], v[148:151], v[160:163], v[8:11]
    v_mfma_f32_16x16x32_bf16 v[12:15], v[148:151], v[164:167], v[12:15]
    ds_read_b128 v[184:187], v210 offset:32768
    s_waitcnt lgkmcnt(11)
    v_mfma_f32_16x16x32_bf16 v[16:19], v[152:155], v[160:163], v[16:19]
    v_mfma_f32_16x16x32_bf16 v[20:23], v[152:155], v[164:167], v[20:23]
    ds_read_b128 v[188:191], v211 offset:32768
    s_waitcnt lgkmcnt(10)
    v_mfma_f32_16x16x32_bf16 v[24:27], v[156:159], v[160:163], v[24:27]
    v_mfma_f32_16x16x32_bf16 v[28:31], v[156:159], v[164:167], v[28:31]
    ds_read_b128 v[192:195], v208 offset:36864
    s_waitcnt lgkmcnt(9)
    v_mfma_f32_16x16x32_bf16 v[32:35], v[168:171], v[160:163], v[32:35]
    v_mfma_f32_16x16x32_bf16 v[36:39], v[168:171], v[164:167], v[36:39]
    ds_read_b128 v[196:199], v209 offset:36864
    s_waitcnt lgkmcnt(8)
    v_mfma_f32_16x16x32_bf16 v[40:43], v[172:175], v[160:163], v[40:43]
    v_mfma_f32_16x16x32_bf16 v[44:47], v[172:175], v[164:167], v[44:47]
    ds_read_b128 v[200:203], v210 offset:36864
    s_waitcnt lgkmcnt(7)
    v_mfma_f32_16x16x32_bf16 v[48:51], v[176:179], v[160:163], v[48:51]
    v_mfma_f32_16x16x32_bf16 v[52:55], v[176:179], v[164:167], v[52:55]
    ds_read_b128 v[204:207], v211 offset:36864
    s_waitcnt lgkmcnt(6)
    v_mfma_f32_16x16x32_bf16 v[56:59], v[180:183], v[160:163], v[56:59]
    v_mfma_f32_16x16x32_bf16 v[60:63], v[180:183], v[164:167], v[60:63]
    s_setprio 3
    v_exp_f32 v128, v128
    v_exp_f32 v129, v129
    v_exp_f32 v130, v130
    v_exp_f32 v131, v131
    v_exp_f32 v132, v132
    s_add_u32 m0, s35, 98304
    s_add_u32 s34, s48, 180224
    buffer_load_dwordx4 v221, s[20:23], s34 offen nt lds
    v_exp_f32 v133, v133
    v_cvt_pk_bf16_f32 v160, v128, v129
    v_cvt_pk_bf16_f32 v161, v130, v131
    v_exp_f32 v134, v134
    v_exp_f32 v135, v135
    ds_read_b128 v[176:179], v208 offset:32768
    v_exp_f32 v136, v136
    v_exp_f32 v137, v137
    v_cvt_pk_bf16_f32 v162, v132, v133
    v_cvt_pk_bf16_f32 v163, v134, v135
    v_exp_f32 v138, v138
    s_add_u32 m0, s35, 32768
    s_add_u32 s34, s48, 196608
    buffer_load_dwordx4 v220, s[16:19], s34 offen nt lds
    v_exp_f32 v139, v139
    v_exp_f32 v140, v140
    v_exp_f32 v141, v141
    v_cvt_pk_bf16_f32 v164, v136, v137
    v_cvt_pk_bf16_f32 v165, v138, v139
    ds_read_b128 v[180:183], v209 offset:32768
    v_exp_f32 v142, v142
    v_exp_f32 v143, v143
    v_cvt_pk_bf16_f32 v166, v140, v141
    v_cvt_pk_bf16_f32 v167, v142, v143
    v_permlane16_swap_b32 v64, v66
    v_permlane16_swap_b32 v65, v67
    v_subrev_u32 v208, 40960, v208
    v_subrev_u32 v209, 40960, v209
    v_subrev_u32 v210, 40960, v210
    v_subrev_u32 v211, 40960, v211
    s_waitcnt lgkmcnt(0)
    s_setprio 0
    v_mfma_f32_16x16x32_bf16 v[128:131], v[176:179], v[96:99], v[240:243]
    ds_read_b64_tr_b16 v[144:145], v212 offset:24576
    v_mfma_f32_16x16x32_bf16 v[136:139], v[176:179], v[100:103], v[244:247]
    ds_read_b64_tr_b16 v[146:147], v212 offset:28672
    v_mfma_f32_16x16x32_bf16 v[128:131], v[180:183], v[104:107], v[128:131]
    ds_read_b64_tr_b16 v[148:149], v213 offset:24576
    v_mfma_f32_16x16x32_bf16 v[136:139], v[180:183], v[108:111], v[136:139]
    ds_read_b64_tr_b16 v[150:151], v213 offset:28672
    v_mfma_f32_16x16x32_bf16 v[128:131], v[184:187], v[112:115], v[128:131]
    ds_read_b64_tr_b16 v[152:153], v214 offset:24576
    v_mfma_f32_16x16x32_bf16 v[136:139], v[184:187], v[116:119], v[136:139]
    ds_read_b64_tr_b16 v[154:155], v214 offset:28672
    v_mfma_f32_16x16x32_bf16 v[128:131], v[188:191], v[120:123], v[128:131]
    ds_read_b64_tr_b16 v[156:157], v215 offset:24576
    v_mfma_f32_16x16x32_bf16 v[136:139], v[188:191], v[124:127], v[136:139]
    ds_read_b64_tr_b16 v[158:159], v215 offset:28672
    v_mfma_f32_16x16x32_bf16 v[132:135], v[192:195], v[96:99], v[240:243]
    s_setprio 1
    ds_read_b64_tr_b16 v[168:169], v216 offset:24576
    v_mfma_f32_16x16x32_bf16 v[140:143], v[192:195], v[100:103], v[244:247]
    ds_read_b64_tr_b16 v[170:171], v216 offset:28672
    v_mfma_f32_16x16x32_bf16 v[132:135], v[196:199], v[104:107], v[132:135]
    ds_read_b64_tr_b16 v[172:173], v217 offset:24576
    v_mfma_f32_16x16x32_bf16 v[140:143], v[196:199], v[108:111], v[140:143]
    ds_read_b64_tr_b16 v[174:175], v217 offset:28672
    v_mfma_f32_16x16x32_bf16 v[132:135], v[200:203], v[112:115], v[132:135]
    ds_read_b64_tr_b16 v[176:177], v218 offset:24576
    v_mfma_f32_16x16x32_bf16 v[140:143], v[200:203], v[116:119], v[140:143]
    ds_read_b64_tr_b16 v[178:179], v218 offset:28672
    v_mfma_f32_16x16x32_bf16 v[132:135], v[204:207], v[120:123], v[132:135]
    ds_read_b64_tr_b16 v[180:181], v219 offset:24576
    v_mfma_f32_16x16x32_bf16 v[140:143], v[204:207], v[124:127], v[140:143]
    ds_read_b64_tr_b16 v[182:183], v219 offset:28672
    v_mfma_f32_16x16x32_bf16 v[226:229], v[248:251], v[160:163], v[226:229]
    v_mfma_f32_16x16x32_bf16 v[252:255], v[248:251], v[164:167], v[252:255]
    s_waitcnt lgkmcnt(14)
    v_mfma_f32_16x16x32_bf16 v[0:3], v[144:147], v[160:163], v[0:3]
    v_mfma_f32_16x16x32_bf16 v[4:7], v[144:147], v[164:167], v[4:7]
    s_waitcnt lgkmcnt(12)
    v_mfma_f32_16x16x32_bf16 v[8:11], v[148:151], v[160:163], v[8:11]
    v_mfma_f32_16x16x32_bf16 v[12:15], v[148:151], v[164:167], v[12:15]
    ds_read_b128 v[184:187], v210 offset:0
    s_waitcnt lgkmcnt(11)
    v_mfma_f32_16x16x32_bf16 v[16:19], v[152:155], v[160:163], v[16:19]
    v_mfma_f32_16x16x32_bf16 v[20:23], v[152:155], v[164:167], v[20:23]
    ds_read_b128 v[188:191], v211 offset:0
    s_waitcnt lgkmcnt(10)
    v_mfma_f32_16x16x32_bf16 v[24:27], v[156:159], v[160:163], v[24:27]
    v_mfma_f32_16x16x32_bf16 v[28:31], v[156:159], v[164:167], v[28:31]
    ds_read_b128 v[192:195], v208 offset:4096
    s_waitcnt lgkmcnt(9)
    v_mfma_f32_16x16x32_bf16 v[32:35], v[168:171], v[160:163], v[32:35]
    v_mfma_f32_16x16x32_bf16 v[36:39], v[168:171], v[164:167], v[36:39]
    ds_read_b128 v[196:199], v209 offset:4096
    s_waitcnt lgkmcnt(8)
    v_mfma_f32_16x16x32_bf16 v[40:43], v[172:175], v[160:163], v[40:43]
    v_mfma_f32_16x16x32_bf16 v[44:47], v[172:175], v[164:167], v[44:47]
    ds_read_b128 v[200:203], v210 offset:4096
    s_waitcnt lgkmcnt(7)
    v_mfma_f32_16x16x32_bf16 v[48:51], v[176:179], v[160:163], v[48:51]
    v_mfma_f32_16x16x32_bf16 v[52:55], v[176:179], v[164:167], v[52:55]
    ds_read_b128 v[204:207], v211 offset:4096
    s_waitcnt lgkmcnt(6)
    v_mfma_f32_16x16x32_bf16 v[56:59], v[180:183], v[160:163], v[56:59]
    v_mfma_f32_16x16x32_bf16 v[60:63], v[180:183], v[164:167], v[60:63]
    s_setprio 3
    s_cbranch_vccz L_g37
    s_waitcnt vmcnt(4)
    s_barrier
L_g37:
    v_exp_f32 v128, v128
    v_exp_f32 v129, v129
    v_exp_f32 v130, v130
    v_exp_f32 v131, v131
    s_add_u32 m0, s35, 106496
    s_add_u32 s34, s48, 188416
    buffer_load_dwordx4 v221, s[20:23], s34 offen nt lds
    v_exp_f32 v132, v132
    v_exp_f32 v133, v133
    v_cvt_pk_bf16_f32 v160, v128, v129
    v_cvt_pk_bf16_f32 v161, v130, v131
    ds_read_b128 v[176:179], v208 offset:0
    v_exp_f32 v134, v134
    v_exp_f32 v135, v135
    v_exp_f32 v136, v136
    v_exp_f32 v137, v137
    s_add_u32 m0, s35, 40960
    s_add_u32 s34, s48, 204800
    buffer_load_dwordx4 v220, s[16:19], s34 offen nt lds
    v_cvt_pk_bf16_f32 v162, v132, v133
    v_cvt_pk_bf16_f32 v163, v134, v135
    v_exp_f32 v138, v138
    v_exp_f32 v139, v139
    ds_read_b128 v[180:183], v209 offset:0
    v_exp_f32 v140, v140
    v_exp_f32 v141, v141
    v_cvt_pk_bf16_f32 v164, v136, v137
    v_cvt_pk_bf16_f32 v165, v138, v139
    buffer_store_dwordx4 v[64:67], v238, s[24:27], 0 offen offset:0 sc0 sc1
    v_exp_f32 v142, v142
    v_exp_f32 v143, v143
    v_cvt_pk_bf16_f32 v166, v140, v141
    v_cvt_pk_bf16_f32 v167, v142, v143
    v_permlane16_swap_b32 v72, v74
    v_permlane16_swap_b32 v73, v75
    s_cbranch_vccnz L_g38
    s_waitcnt vmcnt(7)
    s_barrier
L_g38:
    s_waitcnt lgkmcnt(0)
    s_setprio 0
    v_mfma_f32_16x16x32_bf16 v[128:131], v[176:179], v[96:99], v[240:243]
    ds_read_b64_tr_b16 v[144:145], v212 offset:32768
    v_mfma_f32_16x16x32_bf16 v[136:139], v[176:179], v[100:103], v[244:247]
    ds_read_b64_tr_b16 v[146:147], v212 offset:36864
    v_mfma_f32_16x16x32_bf16 v[128:131], v[180:183], v[104:107], v[128:131]
    ds_read_b64_tr_b16 v[148:149], v213 offset:32768
    v_mfma_f32_16x16x32_bf16 v[136:139], v[180:183], v[108:111], v[136:139]
    ds_read_b64_tr_b16 v[150:151], v213 offset:36864
    v_mfma_f32_16x16x32_bf16 v[128:131], v[184:187], v[112:115], v[128:131]
    ds_read_b64_tr_b16 v[152:153], v214 offset:32768
    v_mfma_f32_16x16x32_bf16 v[136:139], v[184:187], v[116:119], v[136:139]
    ds_read_b64_tr_b16 v[154:155], v214 offset:36864
    v_mfma_f32_16x16x32_bf16 v[128:131], v[188:191], v[120:123], v[128:131]
    ds_read_b64_tr_b16 v[156:157], v215 offset:32768
    v_mfma_f32_16x16x32_bf16 v[136:139], v[188:191], v[124:127], v[136:139]
    ds_read_b64_tr_b16 v[158:159], v215 offset:36864
    v_mfma_f32_16x16x32_bf16 v[132:135], v[192:195], v[96:99], v[240:243]
    s_setprio 1
    ds_read_b64_tr_b16 v[168:169], v216 offset:32768
    v_mfma_f32_16x16x32_bf16 v[140:143], v[192:195], v[100:103], v[244:247]
    ds_read_b64_tr_b16 v[170:171], v216 offset:36864
    v_mfma_f32_16x16x32_bf16 v[132:135], v[196:199], v[104:107], v[132:135]
    ds_read_b64_tr_b16 v[172:173], v217 offset:32768
    v_mfma_f32_16x16x32_bf16 v[140:143], v[196:199], v[108:111], v[140:143]
    ds_read_b64_tr_b16 v[174:175], v217 offset:36864
    v_mfma_f32_16x16x32_bf16 v[132:135], v[200:203], v[112:115], v[132:135]
    ds_read_b64_tr_b16 v[176:177], v218 offset:32768
    v_mfma_f32_16x16x32_bf16 v[140:143], v[200:203], v[116:119], v[140:143]
    ds_read_b64_tr_b16 v[178:179], v218 offset:36864
    v_mfma_f32_16x16x32_bf16 v[132:135], v[204:207], v[120:123], v[132:135]
    ds_read_b64_tr_b16 v[180:181], v219 offset:32768
    v_mfma_f32_16x16x32_bf16 v[140:143], v[204:207], v[124:127], v[140:143]
    ds_read_b64_tr_b16 v[182:183], v219 offset:36864
    v_mfma_f32_16x16x32_bf16 v[226:229], v[248:251], v[160:163], v[226:229]
    v_mfma_f32_16x16x32_bf16 v[252:255], v[248:251], v[164:167], v[252:255]
    s_waitcnt lgkmcnt(14)
    v_mfma_f32_16x16x32_bf16 v[0:3], v[144:147], v[160:163], v[0:3]
    v_mfma_f32_16x16x32_bf16 v[4:7], v[144:147], v[164:167], v[4:7]
    s_waitcnt lgkmcnt(12)
    v_mfma_f32_16x16x32_bf16 v[8:11], v[148:151], v[160:163], v[8:11]
    v_mfma_f32_16x16x32_bf16 v[12:15], v[148:151], v[164:167], v[12:15]
    ds_read_b128 v[184:187], v210 offset:8192
    s_waitcnt lgkmcnt(11)
    v_mfma_f32_16x16x32_bf16 v[16:19], v[152:155], v[160:163], v[16:19]
    v_mfma_f32_16x16x32_bf16 v[20:23], v[152:155], v[164:167], v[20:23]
    ds_read_b128 v[188:191], v211 offset:8192
    s_waitcnt lgkmcnt(10)
    v_mfma_f32_16x16x32_bf16 v[24:27], v[156:159], v[160:163], v[24:27]
    v_mfma_f32_16x16x32_bf16 v[28:31], v[156:159], v[164:167], v[28:31]
    ds_read_b128 v[192:195], v208 offset:12288
    s_waitcnt lgkmcnt(9)
    v_mfma_f32_16x16x32_bf16 v[32:35], v[168:171], v[160:163], v[32:35]
    v_mfma_f32_16x16x32_bf16 v[36:39], v[168:171], v[164:167], v[36:39]
    ds_read_b128 v[196:199], v209 offset:12288
    s_waitcnt lgkmcnt(8)
    v_mfma_f32_16x16x32_bf16 v[40:43], v[172:175], v[160:163], v[40:43]
    v_mfma_f32_16x16x32_bf16 v[44:47], v[172:175], v[164:167], v[44:47]
    ds_read_b128 v[200:203], v210 offset:12288
    s_waitcnt lgkmcnt(7)
    v_mfma_f32_16x16x32_bf16 v[48:51], v[176:179], v[160:163], v[48:51]
    v_mfma_f32_16x16x32_bf16 v[52:55], v[176:179], v[164:167], v[52:55]
    ds_read_b128 v[204:207], v211 offset:12288
    s_waitcnt lgkmcnt(6)
    v_mfma_f32_16x16x32_bf16 v[56:59], v[180:183], v[160:163], v[56:59]
    v_mfma_f32_16x16x32_bf16 v[60:63], v[180:183], v[164:167], v[60:63]
    s_setprio 3
    v_subrev_u32 v212, 40960, v212
    v_subrev_u32 v213, 40960, v213
    v_subrev_u32 v214, 40960, v214
    v_subrev_u32 v215, 40960, v215
    v_subrev_u32 v216, 40960, v216
    v_subrev_u32 v217, 40960, v217
    v_subrev_u32 v218, 40960, v218
    v_subrev_u32 v219, 40960, v219
    v_exp_f32 v128, v128
    v_exp_f32 v129, v129
    v_exp_f32 v130, v130
    v_exp_f32 v131, v131
    s_add_u32 m0, s35, 114688
    s_add_u32 s34, s48, 196608
    buffer_load_dwordx4 v221, s[20:23], s34 offen nt lds
    v_exp_f32 v132, v132
    v_exp_f32 v133, v133
    v_cvt_pk_bf16_f32 v160, v128, v129
    v_cvt_pk_bf16_f32 v161, v130, v131
    ds_read_b128 v[176:179], v208 offset:8192
    v_exp_f32 v134, v134
    v_exp_f32 v135, v135
    v_exp_f32 v136, v136
    v_exp_f32 v137, v137
    s_add_u32 m0, s35, 49152
    s_add_u32 s34, s48, 212992
    buffer_load_dwordx4 v220, s[16:19], s34 offen nt lds
    v_cvt_pk_bf16_f32 v162, v132, v133
    v_cvt_pk_bf16_f32 v163, v134, v135
    v_exp_f32 v138, v138
    v_exp_f32 v139, v139
    ds_read_b128 v[180:183], v209 offset:8192
    v_exp_f32 v140, v140
    v_exp_f32 v141, v141
    v_cvt_pk_bf16_f32 v164, v136, v137
    v_cvt_pk_bf16_f32 v165, v138, v139
    buffer_store_dwordx4 v[72:75], v238, s[24:27], 0 offen offset:64 sc0 sc1
    v_exp_f32 v142, v142
    v_exp_f32 v143, v143
    v_cvt_pk_bf16_f32 v166, v140, v141
    v_cvt_pk_bf16_f32 v167, v142, v143
    s_waitcnt lgkmcnt(0)
    s_setprio 0
    v_mfma_f32_16x16x32_bf16 v[128:131], v[176:179], v[96:99], v[240:243]
    ds_read_b64_tr_b16 v[144:145], v212 offset:0
    v_mfma_f32_16x16x32_bf16 v[136:139], v[176:179], v[100:103], v[244:247]
    ds_read_b64_tr_b16 v[146:147], v212 offset:4096
    v_mfma_f32_16x16x32_bf16 v[128:131], v[180:183], v[104:107], v[128:131]
    ds_read_b64_tr_b16 v[148:149], v213 offset:0
    v_mfma_f32_16x16x32_bf16 v[136:139], v[180:183], v[108:111], v[136:139]
    ds_read_b64_tr_b16 v[150:151], v213 offset:4096
    v_mfma_f32_16x16x32_bf16 v[128:131], v[184:187], v[112:115], v[128:131]
    ds_read_b64_tr_b16 v[152:153], v214 offset:0
    v_mfma_f32_16x16x32_bf16 v[136:139], v[184:187], v[116:119], v[136:139]
    ds_read_b64_tr_b16 v[154:155], v214 offset:4096
    v_mfma_f32_16x16x32_bf16 v[128:131], v[188:191], v[120:123], v[128:131]
    ds_read_b64_tr_b16 v[156:157], v215 offset:0
    v_mfma_f32_16x16x32_bf16 v[136:139], v[188:191], v[124:127], v[136:139]
    ds_read_b64_tr_b16 v[158:159], v215 offset:4096
    v_mfma_f32_16x16x32_bf16 v[132:135], v[192:195], v[96:99], v[240:243]
    s_setprio 1
    ds_read_b64_tr_b16 v[168:169], v216 offset:0
    v_mfma_f32_16x16x32_bf16 v[140:143], v[192:195], v[100:103], v[244:247]
    ds_read_b64_tr_b16 v[170:171], v216 offset:4096
    v_mfma_f32_16x16x32_bf16 v[132:135], v[196:199], v[104:107], v[132:135]
    ds_read_b64_tr_b16 v[172:173], v217 offset:0
    v_mfma_f32_16x16x32_bf16 v[140:143], v[196:199], v[108:111], v[140:143]
    ds_read_b64_tr_b16 v[174:175], v217 offset:4096
    v_mfma_f32_16x16x32_bf16 v[132:135], v[200:203], v[112:115], v[132:135]
    ds_read_b64_tr_b16 v[176:177], v218 offset:0
    v_mfma_f32_16x16x32_bf16 v[140:143], v[200:203], v[116:119], v[140:143]
    ds_read_b64_tr_b16 v[178:179], v218 offset:4096
    v_mfma_f32_16x16x32_bf16 v[132:135], v[204:207], v[120:123], v[132:135]
    ds_read_b64_tr_b16 v[180:181], v219 offset:0
    v_mfma_f32_16x16x32_bf16 v[140:143], v[204:207], v[124:127], v[140:143]
    ds_read_b64_tr_b16 v[182:183], v219 offset:4096
    v_mfma_f32_16x16x32_bf16 v[226:229], v[248:251], v[160:163], v[226:229]
    v_mfma_f32_16x16x32_bf16 v[252:255], v[248:251], v[164:167], v[252:255]
    s_waitcnt lgkmcnt(14)
    v_mfma_f32_16x16x32_bf16 v[0:3], v[144:147], v[160:163], v[0:3]
    v_mfma_f32_16x16x32_bf16 v[4:7], v[144:147], v[164:167], v[4:7]
    s_waitcnt lgkmcnt(12)
    v_mfma_f32_16x16x32_bf16 v[8:11], v[148:151], v[160:163], v[8:11]
    v_mfma_f32_16x16x32_bf16 v[12:15], v[148:151], v[164:167], v[12:15]
    ds_read_b128 v[184:187], v210 offset:16384
    s_waitcnt lgkmcnt(11)
    v_mfma_f32_16x16x32_bf16 v[16:19], v[152:155], v[160:163], v[16:19]
    v_mfma_f32_16x16x32_bf16 v[20:23], v[152:155], v[164:167], v[20:23]
    ds_read_b128 v[188:191], v211 offset:16384
    s_waitcnt lgkmcnt(10)
    v_mfma_f32_16x16x32_bf16 v[24:27], v[156:159], v[160:163], v[24:27]
    v_mfma_f32_16x16x32_bf16 v[28:31], v[156:159], v[164:167], v[28:31]
    ds_read_b128 v[192:195], v208 offset:20480
    s_waitcnt lgkmcnt(9)
    v_mfma_f32_16x16x32_bf16 v[32:35], v[168:171], v[160:163], v[32:35]
    v_mfma_f32_16x16x32_bf16 v[36:39], v[168:171], v[164:167], v[36:39]
    ds_read_b128 v[196:199], v209 offset:20480
    s_waitcnt lgkmcnt(8)
    v_mfma_f32_16x16x32_bf16 v[40:43], v[172:175], v[160:163], v[40:43]
    v_mfma_f32_16x16x32_bf16 v[44:47], v[172:175], v[164:167], v[44:47]
    ds_read_b128 v[200:203], v210 offset:20480
    s_waitcnt lgkmcnt(7)
    v_mfma_f32_16x16x32_bf16 v[48:51], v[176:179], v[160:163], v[48:51]
    v_mfma_f32_16x16x32_bf16 v[52:55], v[176:179], v[164:167], v[52:55]
    ds_read_b128 v[204:207], v211 offset:20480
    s_waitcnt lgkmcnt(6)
    v_mfma_f32_16x16x32_bf16 v[56:59], v[180:183], v[160:163], v[56:59]
    v_mfma_f32_16x16x32_bf16 v[60:63], v[180:183], v[164:167], v[60:63]
    s_setprio 3
    s_cbranch_vccz L_g39
    s_waitcnt vmcnt(6)
    s_barrier
L_g39:
    v_exp_f32 v128, v128
    v_exp_f32 v129, v129
    v_exp_f32 v130, v130
    v_exp_f32 v131, v131
    v_exp_f32 v132, v132
    s_add_u32 m0, s35, 122880
    s_add_u32 s34, s48, 204800
    buffer_load_dwordx4 v221, s[20:23], s34 offen nt lds
    v_exp_f32 v133, v133
    v_cvt_pk_bf16_f32 v160, v128, v129
    v_cvt_pk_bf16_f32 v161, v130, v131
    v_exp_f32 v134, v134
    v_exp_f32 v135, v135
    ds_read_b128 v[176:179], v208 offset:16384
    v_exp_f32 v136, v136
    v_exp_f32 v137, v137
    v_cvt_pk_bf16_f32 v162, v132, v133
    v_cvt_pk_bf16_f32 v163, v134, v135
    v_exp_f32 v138, v138
    s_add_u32 m0, s35, 57344
    s_add_u32 s34, s48, 221184
    buffer_load_dwordx4 v220, s[16:19], s34 offen nt lds
    v_exp_f32 v139, v139
    v_exp_f32 v140, v140
    v_exp_f32 v141, v141
    v_cvt_pk_bf16_f32 v164, v136, v137
    v_cvt_pk_bf16_f32 v165, v138, v139
    ds_read_b128 v[180:183], v209 offset:16384
    v_exp_f32 v142, v142
    v_exp_f32 v143, v143
    v_cvt_pk_bf16_f32 v166, v140, v141
    v_cvt_pk_bf16_f32 v167, v142, v143
    v_permlane16_swap_b32 v68, v70
    v_permlane16_swap_b32 v69, v71
    s_cbranch_vccnz L_g40
    s_waitcnt vmcnt(8)
    s_barrier
L_g40:
    s_waitcnt lgkmcnt(0)
    s_setprio 0
    v_mfma_f32_16x16x32_bf16 v[128:131], v[176:179], v[96:99], v[240:243]
    ds_read_b64_tr_b16 v[144:145], v212 offset:8192
    v_mfma_f32_16x16x32_bf16 v[136:139], v[176:179], v[100:103], v[244:247]
    ds_read_b64_tr_b16 v[146:147], v212 offset:12288
    v_mfma_f32_16x16x32_bf16 v[128:131], v[180:183], v[104:107], v[128:131]
    ds_read_b64_tr_b16 v[148:149], v213 offset:8192
    v_mfma_f32_16x16x32_bf16 v[136:139], v[180:183], v[108:111], v[136:139]
    ds_read_b64_tr_b16 v[150:151], v213 offset:12288
    v_mfma_f32_16x16x32_bf16 v[128:131], v[184:187], v[112:115], v[128:131]
    ds_read_b64_tr_b16 v[152:153], v214 offset:8192
    v_mfma_f32_16x16x32_bf16 v[136:139], v[184:187], v[116:119], v[136:139]
    ds_read_b64_tr_b16 v[154:155], v214 offset:12288
    v_mfma_f32_16x16x32_bf16 v[128:131], v[188:191], v[120:123], v[128:131]
    ds_read_b64_tr_b16 v[156:157], v215 offset:8192
    v_mfma_f32_16x16x32_bf16 v[136:139], v[188:191], v[124:127], v[136:139]
    ds_read_b64_tr_b16 v[158:159], v215 offset:12288
    v_mfma_f32_16x16x32_bf16 v[132:135], v[192:195], v[96:99], v[240:243]
    s_setprio 1
    ds_read_b64_tr_b16 v[168:169], v216 offset:8192
    v_mfma_f32_16x16x32_bf16 v[140:143], v[192:195], v[100:103], v[244:247]
    ds_read_b64_tr_b16 v[170:171], v216 offset:12288
    v_mfma_f32_16x16x32_bf16 v[132:135], v[196:199], v[104:107], v[132:135]
    ds_read_b64_tr_b16 v[172:173], v217 offset:8192
    v_mfma_f32_16x16x32_bf16 v[140:143], v[196:199], v[108:111], v[140:143]
    ds_read_b64_tr_b16 v[174:175], v217 offset:12288
    v_mfma_f32_16x16x32_bf16 v[132:135], v[200:203], v[112:115], v[132:135]
    ds_read_b64_tr_b16 v[176:177], v218 offset:8192
    v_mfma_f32_16x16x32_bf16 v[140:143], v[200:203], v[116:119], v[140:143]
    ds_read_b64_tr_b16 v[178:179], v218 offset:12288
    v_mfma_f32_16x16x32_bf16 v[132:135], v[204:207], v[120:123], v[132:135]
    ds_read_b64_tr_b16 v[180:181], v219 offset:8192
    v_mfma_f32_16x16x32_bf16 v[140:143], v[204:207], v[124:127], v[140:143]
    ds_read_b64_tr_b16 v[182:183], v219 offset:12288
    v_mfma_f32_16x16x32_bf16 v[226:229], v[248:251], v[160:163], v[226:229]
    v_mfma_f32_16x16x32_bf16 v[252:255], v[248:251], v[164:167], v[252:255]
    s_waitcnt lgkmcnt(14)
    v_mfma_f32_16x16x32_bf16 v[0:3], v[144:147], v[160:163], v[0:3]
    v_mfma_f32_16x16x32_bf16 v[4:7], v[144:147], v[164:167], v[4:7]
    s_waitcnt lgkmcnt(12)
    v_mfma_f32_16x16x32_bf16 v[8:11], v[148:151], v[160:163], v[8:11]
    v_mfma_f32_16x16x32_bf16 v[12:15], v[148:151], v[164:167], v[12:15]
    ds_read_b128 v[184:187], v210 offset:24576
    s_waitcnt lgkmcnt(11)
    v_mfma_f32_16x16x32_bf16 v[16:19], v[152:155], v[160:163], v[16:19]
    v_mfma_f32_16x16x32_bf16 v[20:23], v[152:155], v[164:167], v[20:23]
    ds_read_b128 v[188:191], v211 offset:24576
    s_waitcnt lgkmcnt(10)
    v_mfma_f32_16x16x32_bf16 v[24:27], v[156:159], v[160:163], v[24:27]
    v_mfma_f32_16x16x32_bf16 v[28:31], v[156:159], v[164:167], v[28:31]
    ds_read_b128 v[192:195], v208 offset:28672
    s_waitcnt lgkmcnt(9)
    v_mfma_f32_16x16x32_bf16 v[32:35], v[168:171], v[160:163], v[32:35]
    v_mfma_f32_16x16x32_bf16 v[36:39], v[168:171], v[164:167], v[36:39]
    ds_read_b128 v[196:199], v209 offset:28672
    s_waitcnt lgkmcnt(8)
    v_mfma_f32_16x16x32_bf16 v[40:43], v[172:175], v[160:163], v[40:43]
    v_mfma_f32_16x16x32_bf16 v[44:47], v[172:175], v[164:167], v[44:47]
    ds_read_b128 v[200:203], v210 offset:28672
    s_waitcnt lgkmcnt(7)
    v_mfma_f32_16x16x32_bf16 v[48:51], v[176:179], v[160:163], v[48:51]
    v_mfma_f32_16x16x32_bf16 v[52:55], v[176:179], v[164:167], v[52:55]
    ds_read_b128 v[204:207], v211 offset:28672
    s_waitcnt lgkmcnt(6)
    v_mfma_f32_16x16x32_bf16 v[56:59], v[180:183], v[160:163], v[56:59]
    v_mfma_f32_16x16x32_bf16 v[60:63], v[180:183], v[164:167], v[60:63]
    s_setprio 3
    v_exp_f32 v128, v128
    v_exp_f32 v129, v129
    v_exp_f32 v130, v130
    v_exp_f32 v131, v131
    s_add_u32 m0, s35, 131072
    s_add_u32 s34, s48, 212992
    buffer_load_dwordx4 v221, s[20:23], s34 offen nt lds
    v_exp_f32 v132, v132
    v_exp_f32 v133, v133
    v_cvt_pk_bf16_f32 v160, v128, v129
    v_cvt_pk_bf16_f32 v161, v130, v131
    ds_read_b128 v[176:179], v208 offset:24576
    v_exp_f32 v134, v134
    v_exp_f32 v135, v135
    v_exp_f32 v136, v136
    v_exp_f32 v137, v137
    s_add_u32 m0, s49, 65536
    s_add_u32 s34, s48, 229376
    buffer_load_dwordx4 v220, s[16:19], s34 offen nt lds
    v_cvt_pk_bf16_f32 v162, v132, v133
    v_cvt_pk_bf16_f32 v163, v134, v135
    v_exp_f32 v138, v138
    v_exp_f32 v139, v139
    ds_read_b128 v[180:183], v209 offset:24576
    v_exp_f32 v140, v140
    v_exp_f32 v141, v141
    v_cvt_pk_bf16_f32 v164, v136, v137
    v_cvt_pk_bf16_f32 v165, v138, v139
    buffer_store_dwordx4 v[68:71], v238, s[24:27], 0 offen offset:256 sc0 sc1
    v_exp_f32 v142, v142
    v_exp_f32 v143, v143
    v_cvt_pk_bf16_f32 v166, v140, v141
    v_cvt_pk_bf16_f32 v167, v142, v143
    v_permlane16_swap_b32 v76, v78
    v_permlane16_swap_b32 v77, v79
    s_waitcnt lgkmcnt(0)
    s_setprio 0
    v_mfma_f32_16x16x32_bf16 v[128:131], v[176:179], v[96:99], v[240:243]
    ds_read_b64_tr_b16 v[144:145], v212 offset:16384
    v_mfma_f32_16x16x32_bf16 v[136:139], v[176:179], v[100:103], v[244:247]
    ds_read_b64_tr_b16 v[146:147], v212 offset:20480
    v_mfma_f32_16x16x32_bf16 v[128:131], v[180:183], v[104:107], v[128:131]
    ds_read_b64_tr_b16 v[148:149], v213 offset:16384
    v_mfma_f32_16x16x32_bf16 v[136:139], v[180:183], v[108:111], v[136:139]
    ds_read_b64_tr_b16 v[150:151], v213 offset:20480
    v_mfma_f32_16x16x32_bf16 v[128:131], v[184:187], v[112:115], v[128:131]
    ds_read_b64_tr_b16 v[152:153], v214 offset:16384
    v_mfma_f32_16x16x32_bf16 v[136:139], v[184:187], v[116:119], v[136:139]
    ds_read_b64_tr_b16 v[154:155], v214 offset:20480
    v_mfma_f32_16x16x32_bf16 v[128:131], v[188:191], v[120:123], v[128:131]
    ds_read_b64_tr_b16 v[156:157], v215 offset:16384
    v_mfma_f32_16x16x32_bf16 v[136:139], v[188:191], v[124:127], v[136:139]
    ds_read_b64_tr_b16 v[158:159], v215 offset:20480
    v_mfma_f32_16x16x32_bf16 v[132:135], v[192:195], v[96:99], v[240:243]
    s_setprio 1
    ds_read_b64_tr_b16 v[168:169], v216 offset:16384
    v_mfma_f32_16x16x32_bf16 v[140:143], v[192:195], v[100:103], v[244:247]
    ds_read_b64_tr_b16 v[170:171], v216 offset:20480
    v_mfma_f32_16x16x32_bf16 v[132:135], v[196:199], v[104:107], v[132:135]
    ds_read_b64_tr_b16 v[172:173], v217 offset:16384
    v_mfma_f32_16x16x32_bf16 v[140:143], v[196:199], v[108:111], v[140:143]
    ds_read_b64_tr_b16 v[174:175], v217 offset:20480
    v_mfma_f32_16x16x32_bf16 v[132:135], v[200:203], v[112:115], v[132:135]
    ds_read_b64_tr_b16 v[176:177], v218 offset:16384
    v_mfma_f32_16x16x32_bf16 v[140:143], v[200:203], v[116:119], v[140:143]
    ds_read_b64_tr_b16 v[178:179], v218 offset:20480
    v_mfma_f32_16x16x32_bf16 v[132:135], v[204:207], v[120:123], v[132:135]
    ds_read_b64_tr_b16 v[180:181], v219 offset:16384
    v_mfma_f32_16x16x32_bf16 v[140:143], v[204:207], v[124:127], v[140:143]
    ds_read_b64_tr_b16 v[182:183], v219 offset:20480
    v_mfma_f32_16x16x32_bf16 v[226:229], v[248:251], v[160:163], v[226:229]
    v_mfma_f32_16x16x32_bf16 v[252:255], v[248:251], v[164:167], v[252:255]
    s_waitcnt lgkmcnt(14)
    v_mfma_f32_16x16x32_bf16 v[0:3], v[144:147], v[160:163], v[0:3]
    v_mfma_f32_16x16x32_bf16 v[4:7], v[144:147], v[164:167], v[4:7]
    s_waitcnt lgkmcnt(12)
    v_mfma_f32_16x16x32_bf16 v[8:11], v[148:151], v[160:163], v[8:11]
    v_mfma_f32_16x16x32_bf16 v[12:15], v[148:151], v[164:167], v[12:15]
    ds_read_b128 v[184:187], v210 offset:32768
    s_waitcnt lgkmcnt(11)
    v_mfma_f32_16x16x32_bf16 v[16:19], v[152:155], v[160:163], v[16:19]
    v_mfma_f32_16x16x32_bf16 v[20:23], v[152:155], v[164:167], v[20:23]
    ds_read_b128 v[188:191], v211 offset:32768
    s_waitcnt lgkmcnt(10)
    v_mfma_f32_16x16x32_bf16 v[24:27], v[156:159], v[160:163], v[24:27]
    v_mfma_f32_16x16x32_bf16 v[28:31], v[156:159], v[164:167], v[28:31]
    ds_read_b128 v[192:195], v208 offset:36864
    s_waitcnt lgkmcnt(9)
    v_mfma_f32_16x16x32_bf16 v[32:35], v[168:171], v[160:163], v[32:35]
    v_mfma_f32_16x16x32_bf16 v[36:39], v[168:171], v[164:167], v[36:39]
    ds_read_b128 v[196:199], v209 offset:36864
    s_waitcnt lgkmcnt(8)
    v_mfma_f32_16x16x32_bf16 v[40:43], v[172:175], v[160:163], v[40:43]
    v_mfma_f32_16x16x32_bf16 v[44:47], v[172:175], v[164:167], v[44:47]
    ds_read_b128 v[200:203], v210 offset:36864
    s_waitcnt lgkmcnt(7)
    v_mfma_f32_16x16x32_bf16 v[48:51], v[176:179], v[160:163], v[48:51]
    v_mfma_f32_16x16x32_bf16 v[52:55], v[176:179], v[164:167], v[52:55]
    ds_read_b128 v[204:207], v211 offset:36864
    s_waitcnt lgkmcnt(6)
    v_mfma_f32_16x16x32_bf16 v[56:59], v[180:183], v[160:163], v[56:59]
    v_mfma_f32_16x16x32_bf16 v[60:63], v[180:183], v[164:167], v[60:63]
    s_setprio 3
    s_cbranch_vccz L_g41
    s_waitcnt vmcnt(6)
    s_barrier
L_g41:
    v_exp_f32 v128, v128
    v_exp_f32 v129, v129
    v_exp_f32 v130, v130
    v_exp_f32 v131, v131
    s_add_u32 m0, s35, 139264
    s_add_u32 s34, s48, 221184
    buffer_load_dwordx4 v221, s[20:23], s34 offen nt lds
    v_exp_f32 v132, v132
    v_exp_f32 v133, v133
    v_cvt_pk_bf16_f32 v160, v128, v129
    v_cvt_pk_bf16_f32 v161, v130, v131
    ds_read_b128 v[176:179], v208 offset:32768
    v_exp_f32 v134, v134
    v_exp_f32 v135, v135
    v_exp_f32 v136, v136
    v_exp_f32 v137, v137
    s_add_u32 m0, s49, 73728
    s_add_u32 s34, s48, 237568
    buffer_load_dwordx4 v220, s[16:19], s34 offen nt lds
    v_cvt_pk_bf16_f32 v162, v132, v133
    v_cvt_pk_bf16_f32 v163, v134, v135
    v_exp_f32 v138, v138
    v_exp_f32 v139, v139
    ds_read_b128 v[180:183], v209 offset:32768
    v_exp_f32 v140, v140
    v_exp_f32 v141, v141
    v_cvt_pk_bf16_f32 v164, v136, v137
    v_cvt_pk_bf16_f32 v165, v138, v139
    buffer_store_dwordx4 v[76:79], v238, s[24:27], 0 offen offset:320 sc0 sc1
    v_exp_f32 v142, v142
    v_exp_f32 v143, v143
    v_cvt_pk_bf16_f32 v166, v140, v141
    v_cvt_pk_bf16_f32 v167, v142, v143
    v_add_u32 v208, 40960, v208
    v_add_u32 v209, 40960, v209
    v_add_u32 v210, 40960, v210
    v_add_u32 v211, 40960, v211
    s_cbranch_vccnz L_g42
    s_waitcnt vmcnt(9)
    s_barrier
L_g42:
    s_waitcnt lgkmcnt(0)
    s_setprio 0
    v_mfma_f32_16x16x32_bf16 v[128:131], v[176:179], v[96:99], v[240:243]
    ds_read_b64_tr_b16 v[144:145], v212 offset:24576
    v_mfma_f32_16x16x32_bf16 v[136:139], v[176:179], v[100:103], v[244:247]
    ds_read_b64_tr_b16 v[146:147], v212 offset:28672
    v_mfma_f32_16x16x32_bf16 v[128:131], v[180:183], v[104:107], v[128:131]
    ds_read_b64_tr_b16 v[148:149], v213 offset:24576
    v_mfma_f32_16x16x32_bf16 v[136:139], v[180:183], v[108:111], v[136:139]
    ds_read_b64_tr_b16 v[150:151], v213 offset:28672
    v_mfma_f32_16x16x32_bf16 v[128:131], v[184:187], v[112:115], v[128:131]
    ds_read_b64_tr_b16 v[152:153], v214 offset:24576
    v_mfma_f32_16x16x32_bf16 v[136:139], v[184:187], v[116:119], v[136:139]
    ds_read_b64_tr_b16 v[154:155], v214 offset:28672
    v_mfma_f32_16x16x32_bf16 v[128:131], v[188:191], v[120:123], v[128:131]
    ds_read_b64_tr_b16 v[156:157], v215 offset:24576
    v_mfma_f32_16x16x32_bf16 v[136:139], v[188:191], v[124:127], v[136:139]
    ds_read_b64_tr_b16 v[158:159], v215 offset:28672
    v_mfma_f32_16x16x32_bf16 v[132:135], v[192:195], v[96:99], v[240:243]
    s_setprio 1
    ds_read_b64_tr_b16 v[168:169], v216 offset:24576
    v_mfma_f32_16x16x32_bf16 v[140:143], v[192:195], v[100:103], v[244:247]
    ds_read_b64_tr_b16 v[170:171], v216 offset:28672
    v_mfma_f32_16x16x32_bf16 v[132:135], v[196:199], v[104:107], v[132:135]
    ds_read_b64_tr_b16 v[172:173], v217 offset:24576
    v_mfma_f32_16x16x32_bf16 v[140:143], v[196:199], v[108:111], v[140:143]
    ds_read_b64_tr_b16 v[174:175], v217 offset:28672
    v_mfma_f32_16x16x32_bf16 v[132:135], v[200:203], v[112:115], v[132:135]
    ds_read_b64_tr_b16 v[176:177], v218 offset:24576
    v_mfma_f32_16x16x32_bf16 v[140:143], v[200:203], v[116:119], v[140:143]
    ds_read_b64_tr_b16 v[178:179], v218 offset:28672
    v_mfma_f32_16x16x32_bf16 v[132:135], v[204:207], v[120:123], v[132:135]
    ds_read_b64_tr_b16 v[180:181], v219 offset:24576
    v_mfma_f32_16x16x32_bf16 v[140:143], v[204:207], v[124:127], v[140:143]
    ds_read_b64_tr_b16 v[182:183], v219 offset:28672
    v_mfma_f32_16x16x32_bf16 v[226:229], v[248:251], v[160:163], v[226:229]
    v_mfma_f32_16x16x32_bf16 v[252:255], v[248:251], v[164:167], v[252:255]
    s_waitcnt lgkmcnt(14)
    v_mfma_f32_16x16x32_bf16 v[0:3], v[144:147], v[160:163], v[0:3]
    v_mfma_f32_16x16x32_bf16 v[4:7], v[144:147], v[164:167], v[4:7]
    s_waitcnt lgkmcnt(12)
    v_mfma_f32_16x16x32_bf16 v[8:11], v[148:151], v[160:163], v[8:11]
    v_mfma_f32_16x16x32_bf16 v[12:15], v[148:151], v[164:167], v[12:15]
    ds_read_b128 v[184:187], v210 offset:0
    s_waitcnt lgkmcnt(11)
    v_mfma_f32_16x16x32_bf16 v[16:19], v[152:155], v[160:163], v[16:19]
    v_mfma_f32_16x16x32_bf16 v[20:23], v[152:155], v[164:167], v[20:23]
    ds_read_b128 v[188:191], v211 offset:0
    s_waitcnt lgkmcnt(10)
    v_mfma_f32_16x16x32_bf16 v[24:27], v[156:159], v[160:163], v[24:27]
    v_mfma_f32_16x16x32_bf16 v[28:31], v[156:159], v[164:167], v[28:31]
    ds_read_b128 v[192:195], v208 offset:4096
    s_waitcnt lgkmcnt(9)
    v_mfma_f32_16x16x32_bf16 v[32:35], v[168:171], v[160:163], v[32:35]
    v_mfma_f32_16x16x32_bf16 v[36:39], v[168:171], v[164:167], v[36:39]
    ds_read_b128 v[196:199], v209 offset:4096
    s_waitcnt lgkmcnt(8)
    v_mfma_f32_16x16x32_bf16 v[40:43], v[172:175], v[160:163], v[40:43]
    v_mfma_f32_16x16x32_bf16 v[44:47], v[172:175], v[164:167], v[44:47]
    ds_read_b128 v[200:203], v210 offset:4096
    s_waitcnt lgkmcnt(7)
    v_mfma_f32_16x16x32_bf16 v[48:51], v[176:179], v[160:163], v[48:51]
    v_mfma_f32_16x16x32_bf16 v[52:55], v[176:179], v[164:167], v[52:55]
    ds_read_b128 v[204:207], v211 offset:4096
    s_waitcnt lgkmcnt(6)
    v_mfma_f32_16x16x32_bf16 v[56:59], v[180:183], v[160:163], v[56:59]
    v_mfma_f32_16x16x32_bf16 v[60:63], v[180:183], v[164:167], v[60:63]
    s_setprio 3
    v_exp_f32 v128, v128
    v_exp_f32 v129, v129
    v_exp_f32 v130, v130
    v_exp_f32 v131, v131
    v_exp_f32 v132, v132
    s_add_u32 m0, s49, 147456
    s_add_u32 s34, s48, 229376
    buffer_load_dwordx4 v221, s[20:23], s34 offen nt lds
    v_exp_f32 v133, v133
    v_cvt_pk_bf16_f32 v160, v128, v129
    v_cvt_pk_bf16_f32 v161, v130, v131
    v_exp_f32 v134, v134
    v_exp_f32 v135, v135
    ds_read_b128 v[176:179], v208 offset:0
    v_exp_f32 v136, v136
    v_exp_f32 v137, v137
    v_cvt_pk_bf16_f32 v162, v132, v133
    v_cvt_pk_bf16_f32 v163, v134, v135
    v_exp_f32 v138, v138
    s_cbranch_vccnz L_g3
    s_add_u32 m0, s33, 0
    s_mov_b32 s34, 245760
    buffer_load_dwordx4 v220, s[16:19], s34 offen nt lds
L_g3:
    v_exp_f32 v139, v139
    v_exp_f32 v140, v140
    v_exp_f32 v141, v141
    v_cvt_pk_bf16_f32 v164, v136, v137
    v_cvt_pk_bf16_f32 v165, v138, v139
    ds_read_b128 v[180:183], v209 offset:0
    v_exp_f32 v142, v142
    v_exp_f32 v143, v143
    v_cvt_pk_bf16_f32 v166, v140, v141
    v_cvt_pk_bf16_f32 v167, v142, v143
    v_permlane16_swap_b32 v80, v82
    v_permlane16_swap_b32 v81, v83
    s_waitcnt lgkmcnt(0)
    s_setprio 0
    v_mfma_f32_16x16x32_bf16 v[128:131], v[176:179], v[96:99], v[240:243]
    ds_read_b64_tr_b16 v[144:145], v212 offset:32768
    v_mfma_f32_16x16x32_bf16 v[136:139], v[176:179], v[100:103], v[244:247]
    ds_read_b64_tr_b16 v[146:147], v212 offset:36864
    v_mfma_f32_16x16x32_bf16 v[128:131], v[180:183], v[104:107], v[128:131]
    ds_read_b64_tr_b16 v[148:149], v213 offset:32768
    v_mfma_f32_16x16x32_bf16 v[136:139], v[180:183], v[108:111], v[136:139]
    ds_read_b64_tr_b16 v[150:151], v213 offset:36864
    v_mfma_f32_16x16x32_bf16 v[128:131], v[184:187], v[112:115], v[128:131]
    ds_read_b64_tr_b16 v[152:153], v214 offset:32768
    v_mfma_f32_16x16x32_bf16 v[136:139], v[184:187], v[116:119], v[136:139]
    ds_read_b64_tr_b16 v[154:155], v214 offset:36864
    v_mfma_f32_16x16x32_bf16 v[128:131], v[188:191], v[120:123], v[128:131]
    ds_read_b64_tr_b16 v[156:157], v215 offset:32768
    v_mfma_f32_16x16x32_bf16 v[136:139], v[188:191], v[124:127], v[136:139]
    ds_read_b64_tr_b16 v[158:159], v215 offset:36864
    v_mfma_f32_16x16x32_bf16 v[132:135], v[192:195], v[96:99], v[240:243]
    s_setprio 1
    ds_read_b64_tr_b16 v[168:169], v216 offset:32768
    v_mfma_f32_16x16x32_bf16 v[140:143], v[192:195], v[100:103], v[244:247]
    ds_read_b64_tr_b16 v[170:171], v216 offset:36864
    v_mfma_f32_16x16x32_bf16 v[132:135], v[196:199], v[104:107], v[132:135]
    ds_read_b64_tr_b16 v[172:173], v217 offset:32768
    v_mfma_f32_16x16x32_bf16 v[140:143], v[196:199], v[108:111], v[140:143]
    ds_read_b64_tr_b16 v[174:175], v217 offset:36864
    v_mfma_f32_16x16x32_bf16 v[132:135], v[200:203], v[112:115], v[132:135]
    ds_read_b64_tr_b16 v[176:177], v218 offset:32768
    v_mfma_f32_16x16x32_bf16 v[140:143], v[200:203], v[116:119], v[140:143]
    ds_read_b64_tr_b16 v[178:179], v218 offset:36864
    v_mfma_f32_16x16x32_bf16 v[132:135], v[204:207], v[120:123], v[132:135]
    ds_read_b64_tr_b16 v[180:181], v219 offset:32768
    v_mfma_f32_16x16x32_bf16 v[140:143], v[204:207], v[124:127], v[140:143]
    ds_read_b64_tr_b16 v[182:183], v219 offset:36864
    v_mfma_f32_16x16x32_bf16 v[226:229], v[248:251], v[160:163], v[226:229]
    v_mfma_f32_16x16x32_bf16 v[252:255], v[248:251], v[164:167], v[252:255]
    s_waitcnt lgkmcnt(14)
    v_mfma_f32_16x16x32_bf16 v[0:3], v[144:147], v[160:163], v[0:3]
    v_mfma_f32_16x16x32_bf16 v[4:7], v[144:147], v[164:167], v[4:7]
    s_waitcnt lgkmcnt(12)
    v_mfma_f32_16x16x32_bf16 v[8:11], v[148:151], v[160:163], v[8:11]
    v_mfma_f32_16x16x32_bf16 v[12:15], v[148:151], v[164:167], v[12:15]
    ds_read_b128 v[184:187], v210 offset:8192
    s_waitcnt lgkmcnt(11)
    v_mfma_f32_16x16x32_bf16 v[16:19], v[152:155], v[160:163], v[16:19]
    v_mfma_f32_16x16x32_bf16 v[20:23], v[152:155], v[164:167], v[20:23]
    ds_read_b128 v[188:191], v211 offset:8192
    s_waitcnt lgkmcnt(10)
    v_mfma_f32_16x16x32_bf16 v[24:27], v[156:159], v[160:163], v[24:27]
    v_mfma_f32_16x16x32_bf16 v[28:31], v[156:159], v[164:167], v[28:31]
    ds_read_b128 v[192:195], v208 offset:12288
    s_waitcnt lgkmcnt(9)
    v_mfma_f32_16x16x32_bf16 v[32:35], v[168:171], v[160:163], v[32:35]
    v_mfma_f32_16x16x32_bf16 v[36:39], v[168:171], v[164:167], v[36:39]
    ds_read_b128 v[196:199], v209 offset:12288
    s_waitcnt lgkmcnt(8)
    v_mfma_f32_16x16x32_bf16 v[40:43], v[172:175], v[160:163], v[40:43]
    v_mfma_f32_16x16x32_bf16 v[44:47], v[172:175], v[164:167], v[44:47]
    ds_read_b128 v[200:203], v210 offset:12288
    s_waitcnt lgkmcnt(7)
    v_mfma_f32_16x16x32_bf16 v[48:51], v[176:179], v[160:163], v[48:51]
    v_mfma_f32_16x16x32_bf16 v[52:55], v[176:179], v[164:167], v[52:55]
    ds_read_b128 v[204:207], v211 offset:12288
    s_waitcnt lgkmcnt(6)
    v_mfma_f32_16x16x32_bf16 v[56:59], v[180:183], v[160:163], v[56:59]
    v_mfma_f32_16x16x32_bf16 v[60:63], v[180:183], v[164:167], v[60:63]
    s_setprio 3
    s_cbranch_vccz L_g43
    s_waitcnt vmcnt(5)
    s_barrier
L_g43:
    v_add_u32 v212, 40960, v212
    v_add_u32 v213, 40960, v213
    v_add_u32 v214, 40960, v214
    v_add_u32 v215, 40960, v215
    v_add_u32 v216, 40960, v216
    v_add_u32 v217, 40960, v217
    v_add_u32 v218, 40960, v218
    v_add_u32 v219, 40960, v219
    v_exp_f32 v128, v128
    v_exp_f32 v129, v129
    v_exp_f32 v130, v130
    v_exp_f32 v131, v131
    s_add_u32 m0, s49, 155648
    s_add_u32 s34, s48, 237568
    buffer_load_dwordx4 v221, s[20:23], s34 offen nt lds
    v_exp_f32 v132, v132
    v_exp_f32 v133, v133
    v_cvt_pk_bf16_f32 v160, v128, v129
    v_cvt_pk_bf16_f32 v161, v130, v131
    ds_read_b128 v[176:179], v208 offset:8192
    v_exp_f32 v134, v134
    v_exp_f32 v135, v135
    v_exp_f32 v136, v136
    v_exp_f32 v137, v137
    s_cbranch_vccnz L_g4
    s_add_u32 m0, s33, 8192
    s_mov_b32 s34, 253952
    buffer_load_dwordx4 v220, s[16:19], s34 offen nt lds
L_g4:
    v_cvt_pk_bf16_f32 v162, v132, v133
    v_cvt_pk_bf16_f32 v163, v134, v135
    v_exp_f32 v138, v138
    v_exp_f32 v139, v139
    ds_read_b128 v[180:183], v209 offset:8192
    v_exp_f32 v140, v140
    v_exp_f32 v141, v141
    v_cvt_pk_bf16_f32 v164, v136, v137
    v_cvt_pk_bf16_f32 v165, v138, v139
    buffer_store_dwordx4 v[80:83], v238, s[24:27], 0 offen offset:128 sc0 sc1
    v_exp_f32 v142, v142
    v_exp_f32 v143, v143
    v_cvt_pk_bf16_f32 v166, v140, v141
    v_cvt_pk_bf16_f32 v167, v142, v143
    v_permlane16_swap_b32 v88, v90
    v_permlane16_swap_b32 v89, v91
    s_cbranch_vccnz L_g44
    s_waitcnt vmcnt(9)
    s_barrier
L_g44:
    s_waitcnt lgkmcnt(0)
    s_setprio 0
    v_mfma_f32_16x16x32_bf16 v[128:131], v[176:179], v[96:99], v[240:243]
    ds_read_b64_tr_b16 v[144:145], v212 offset:0
    v_mfma_f32_16x16x32_bf16 v[136:139], v[176:179], v[100:103], v[244:247]
    ds_read_b64_tr_b16 v[146:147], v212 offset:4096
    v_mfma_f32_16x16x32_bf16 v[128:131], v[180:183], v[104:107], v[128:131]
    ds_read_b64_tr_b16 v[148:149], v213 offset:0
    v_mfma_f32_16x16x32_bf16 v[136:139], v[180:183], v[108:111], v[136:139]
    ds_read_b64_tr_b16 v[150:151], v213 offset:4096
    v_mfma_f32_16x16x32_bf16 v[128:131], v[184:187], v[112:115], v[128:131]
    ds_read_b64_tr_b16 v[152:153], v214 offset:0
    v_mfma_f32_16x16x32_bf16 v[136:139], v[184:187], v[116:119], v[136:139]
    ds_read_b64_tr_b16 v[154:155], v214 offset:4096
    v_mfma_f32_16x16x32_bf16 v[128:131], v[188:191], v[120:123], v[128:131]
    ds_read_b64_tr_b16 v[156:157], v215 offset:0
    v_mfma_f32_16x16x32_bf16 v[136:139], v[188:191], v[124:127], v[136:139]
    ds_read_b64_tr_b16 v[158:159], v215 offset:4096
    v_mfma_f32_16x16x32_bf16 v[132:135], v[192:195], v[96:99], v[240:243]
    s_setprio 1
    ds_read_b64_tr_b16 v[168:169], v216 offset:0
    v_mfma_f32_16x16x32_bf16 v[140:143], v[192:195], v[100:103], v[244:247]
    ds_read_b64_tr_b16 v[170:171], v216 offset:4096
    v_mfma_f32_16x16x32_bf16 v[132:135], v[196:199], v[104:107], v[132:135]
    ds_read_b64_tr_b16 v[172:173], v217 offset:0
    v_mfma_f32_16x16x32_bf16 v[140:143], v[196:199], v[108:111], v[140:143]
    ds_read_b64_tr_b16 v[174:175], v217 offset:4096
    v_mfma_f32_16x16x32_bf16 v[132:135], v[200:203], v[112:115], v[132:135]
    ds_read_b64_tr_b16 v[176:177], v218 offset:0
    v_mfma_f32_16x16x32_bf16 v[140:143], v[200:203], v[116:119], v[140:143]
    ds_read_b64_tr_b16 v[178:179], v218 offset:4096
    v_mfma_f32_16x16x32_bf16 v[132:135], v[204:207], v[120:123], v[132:135]
    ds_read_b64_tr_b16 v[180:181], v219 offset:0
    v_mfma_f32_16x16x32_bf16 v[140:143], v[204:207], v[124:127], v[140:143]
    ds_read_b64_tr_b16 v[182:183], v219 offset:4096
    v_mfma_f32_16x16x32_bf16 v[226:229], v[248:251], v[160:163], v[226:229]
    v_mfma_f32_16x16x32_bf16 v[252:255], v[248:251], v[164:167], v[252:255]
    s_waitcnt lgkmcnt(14)
    v_mfma_f32_16x16x32_bf16 v[0:3], v[144:147], v[160:163], v[0:3]
    v_mfma_f32_16x16x32_bf16 v[4:7], v[144:147], v[164:167], v[4:7]
    s_waitcnt lgkmcnt(12)
    v_mfma_f32_16x16x32_bf16 v[8:11], v[148:151], v[160:163], v[8:11]
    v_mfma_f32_16x16x32_bf16 v[12:15], v[148:151], v[164:167], v[12:15]
    ds_read_b128 v[184:187], v210 offset:16384
    s_waitcnt lgkmcnt(11)
    v_mfma_f32_16x16x32_bf16 v[16:19], v[152:155], v[160:163], v[16:19]
    v_mfma_f32_16x16x32_bf16 v[20:23], v[152:155], v[164:167], v[20:23]
    ds_read_b128 v[188:191], v211 offset:16384
    s_waitcnt lgkmcnt(10)
    v_mfma_f32_16x16x32_bf16 v[24:27], v[156:159], v[160:163], v[24:27]
    v_mfma_f32_16x16x32_bf16 v[28:31], v[156:159], v[164:167], v[28:31]
    ds_read_b128 v[192:195], v208 offset:20480
    s_waitcnt lgkmcnt(9)
    v_mfma_f32_16x16x32_bf16 v[32:35], v[168:171], v[160:163], v[32:35]
    v_mfma_f32_16x16x32_bf16 v[36:39], v[168:171], v[164:167], v[36:39]
    ds_read_b128 v[196:199], v209 offset:20480
    s_waitcnt lgkmcnt(8)
    v_mfma_f32_16x16x32_bf16 v[40:43], v[172:175], v[160:163], v[40:43]
    v_mfma_f32_16x16x32_bf16 v[44:47], v[172:175], v[164:167], v[44:47]
    ds_read_b128 v[200:203], v210 offset:20480
    s_waitcnt lgkmcnt(7)
    v_mfma_f32_16x16x32_bf16 v[48:51], v[176:179], v[160:163], v[48:51]
    v_mfma_f32_16x16x32_bf16 v[52:55], v[176:179], v[164:167], v[52:55]
    ds_read_b128 v[204:207], v211 offset:20480
    s_waitcnt lgkmcnt(6)
    v_mfma_f32_16x16x32_bf16 v[56:59], v[180:183], v[160:163], v[56:59]
    v_mfma_f32_16x16x32_bf16 v[60:63], v[180:183], v[164:167], v[60:63]
    s_setprio 3
    v_exp_f32 v128, v128
    v_exp_f32 v129, v129
    v_exp_f32 v130, v130
    v_exp_f32 v131, v131
    s_cbranch_vccnz L_g5
    s_add_u32 m0, s33, 81920
    s_mov_b32 s34, 245760
    buffer_load_dwordx4 v221, s[20:23], s34 offen nt lds
L_g5:
    v_exp_f32 v132, v132
    v_exp_f32 v133, v133
    v_cvt_pk_bf16_f32 v160, v128, v129
    v_cvt_pk_bf16_f32 v161, v130, v131
    ds_read_b128 v[176:179], v208 offset:16384
    v_exp_f32 v134, v134
    v_exp_f32 v135, v135
    v_exp_f32 v136, v136
    v_exp_f32 v137, v137
    s_cbranch_vccnz L_g6
    s_add_u32 m0, s33, 90112
    s_mov_b32 s34, 253952
    buffer_load_dwordx4 v221, s[20:23], s34 offen nt lds
L_g6:
    v_cvt_pk_bf16_f32 v162, v132, v133
    v_cvt_pk_bf16_f32 v163, v134, v135
    v_exp_f32 v138, v138
    v_exp_f32 v139, v139
    ds_read_b128 v[180:183], v209 offset:16384
    v_exp_f32 v140, v140
    v_exp_f32 v141, v141
    v_cvt_pk_bf16_f32 v164, v136, v137
    v_cvt_pk_bf16_f32 v165, v138, v139
    buffer_store_dwordx4 v[88:91], v238, s[24:27], 0 offen offset:192 sc0 sc1
    v_exp_f32 v142, v142
    v_exp_f32 v143, v143
    v_cvt_pk_bf16_f32 v166, v140, v141
    v_cvt_pk_bf16_f32 v167, v142, v143
    s_waitcnt lgkmcnt(0)
    s_setprio 0
    v_mfma_f32_16x16x32_bf16 v[128:131], v[176:179], v[96:99], v[240:243]
    ds_read_b64_tr_b16 v[144:145], v212 offset:8192
    v_mfma_f32_16x16x32_bf16 v[136:139], v[176:179], v[100:103], v[244:247]
    ds_read_b64_tr_b16 v[146:147], v212 offset:12288
    v_mfma_f32_16x16x32_bf16 v[128:131], v[180:183], v[104:107], v[128:131]
    ds_read_b64_tr_b16 v[148:149], v213 offset:8192
    v_mfma_f32_16x16x32_bf16 v[136:139], v[180:183], v[108:111], v[136:139]
    ds_read_b64_tr_b16 v[150:151], v213 offset:12288
    v_mfma_f32_16x16x32_bf16 v[128:131], v[184:187], v[112:115], v[128:131]
    ds_read_b64_tr_b16 v[152:153], v214 offset:8192
    v_mfma_f32_16x16x32_bf16 v[136:139], v[184:187], v[116:119], v[136:139]
    ds_read_b64_tr_b16 v[154:155], v214 offset:12288
    v_mfma_f32_16x16x32_bf16 v[128:131], v[188:191], v[120:123], v[128:131]
    ds_read_b64_tr_b16 v[156:157], v215 offset:8192
    v_mfma_f32_16x16x32_bf16 v[136:139], v[188:191], v[124:127], v[136:139]
    ds_read_b64_tr_b16 v[158:159], v215 offset:12288
    v_mfma_f32_16x16x32_bf16 v[132:135], v[192:195], v[96:99], v[240:243]
    s_setprio 1
    ds_read_b64_tr_b16 v[168:169], v216 offset:8192
    v_mfma_f32_16x16x32_bf16 v[140:143], v[192:195], v[100:103], v[244:247]
    ds_read_b64_tr_b16 v[170:171], v216 offset:12288
    v_mfma_f32_16x16x32_bf16 v[132:135], v[196:199], v[104:107], v[132:135]
    ds_read_b64_tr_b16 v[172:173], v217 offset:8192
    v_mfma_f32_16x16x32_bf16 v[140:143], v[196:199], v[108:111], v[140:143]
    ds_read_b64_tr_b16 v[174:175], v217 offset:12288
    v_mfma_f32_16x16x32_bf16 v[132:135], v[200:203], v[112:115], v[132:135]
    ds_read_b64_tr_b16 v[176:177], v218 offset:8192
    v_mfma_f32_16x16x32_bf16 v[140:143], v[200:203], v[116:119], v[140:143]
    ds_read_b64_tr_b16 v[178:179], v218 offset:12288
    v_mfma_f32_16x16x32_bf16 v[132:135], v[204:207], v[120:123], v[132:135]
    ds_read_b64_tr_b16 v[180:181], v219 offset:8192
    v_mfma_f32_16x16x32_bf16 v[140:143], v[204:207], v[124:127], v[140:143]
    ds_read_b64_tr_b16 v[182:183], v219 offset:12288
    v_mfma_f32_16x16x32_bf16 v[226:229], v[248:251], v[160:163], v[226:229]
    v_mfma_f32_16x16x32_bf16 v[252:255], v[248:251], v[164:167], v[252:255]
    s_waitcnt lgkmcnt(14)
    v_mfma_f32_16x16x32_bf16 v[0:3], v[144:147], v[160:163], v[0:3]
    v_mfma_f32_16x16x32_bf16 v[4:7], v[144:147], v[164:167], v[4:7]
    s_waitcnt lgkmcnt(12)
    v_mfma_f32_16x16x32_bf16 v[8:11], v[148:151], v[160:163], v[8:11]
    v_mfma_f32_16x16x32_bf16 v[12:15], v[148:151], v[164:167], v[12:15]
    ds_read_b128 v[184:187], v210 offset:24576
    s_waitcnt lgkmcnt(11)
    v_mfma_f32_16x16x32_bf16 v[16:19], v[152:155], v[160:163], v[16:19]
    v_mfma_f32_16x16x32_bf16 v[20:23], v[152:155], v[164:167], v[20:23]
    ds_read_b128 v[188:191], v211 offset:24576
    s_waitcnt lgkmcnt(10)
    v_mfma_f32_16x16x32_bf16 v[24:27], v[156:159], v[160:163], v[24:27]
    v_mfma_f32_16x16x32_bf16 v[28:31], v[156:159], v[164:167], v[28:31]
    ds_read_b128 v[192:195], v208 offset:28672
    s_waitcnt lgkmcnt(9)
    v_mfma_f32_16x16x32_bf16 v[32:35], v[168:171], v[160:163], v[32:35]
    v_mfma_f32_16x16x32_bf16 v[36:39], v[168:171], v[164:167], v[36:39]
    ds_read_b128 v[196:199], v209 offset:28672
    s_waitcnt lgkmcnt(8)
    v_mfma_f32_16x16x32_bf16 v[40:43], v[172:175], v[160:163], v[40:43]
    v_mfma_f32_16x16x32_bf16 v[44:47], v[172:175], v[164:167], v[44:47]
    ds_read_b128 v[200:203], v210 offset:28672
    s_waitcnt lgkmcnt(7)
    v_mfma_f32_16x16x32_bf16 v[48:51], v[176:179], v[160:163], v[48:51]
    v_mfma_f32_16x16x32_bf16 v[52:55], v[176:179], v[164:167], v[52:55]
    ds_read_b128 v[204:207], v211 offset:28672
    s_waitcnt lgkmcnt(6)
    v_mfma_f32_16x16x32_bf16 v[56:59], v[180:183], v[160:163], v[56:59]
    v_mfma_f32_16x16x32_bf16 v[60:63], v[180:183], v[164:167], v[60:63]
    s_setprio 3
    s_cbranch_vccz L_g45
    s_waitcnt vmcnt(2)
    s_barrier
L_g45:
    v_exp_f32 v128, v128
    v_exp_f32 v129, v129
    v_exp_f32 v130, v130
    v_exp_f32 v131, v131
    v_exp_f32 v132, v132
    v_exp_f32 v133, v133
    v_cvt_pk_bf16_f32 v160, v128, v129
    v_cvt_pk_bf16_f32 v161, v130, v131
    v_exp_f32 v134, v134
    v_exp_f32 v135, v135
    ds_read_b128 v[176:179], v208 offset:24576
    v_exp_f32 v136, v136
    v_exp_f32 v137, v137
    v_cvt_pk_bf16_f32 v162, v132, v133
    v_cvt_pk_bf16_f32 v163, v134, v135
    v_exp_f32 v138, v138
    v_exp_f32 v139, v139
    v_exp_f32 v140, v140
    v_exp_f32 v141, v141
    v_cvt_pk_bf16_f32 v164, v136, v137
    v_cvt_pk_bf16_f32 v165, v138, v139
    ds_read_b128 v[180:183], v209 offset:24576
    v_exp_f32 v142, v142
    v_exp_f32 v143, v143
    v_cvt_pk_bf16_f32 v166, v140, v141
    v_cvt_pk_bf16_f32 v167, v142, v143
    v_permlane16_swap_b32 v84, v86
    v_permlane16_swap_b32 v85, v87
    s_cbranch_vccnz L_g46
    s_waitcnt vmcnt(6)
    s_barrier
L_g46:
    s_waitcnt lgkmcnt(0)
    s_setprio 0
    v_mfma_f32_16x16x32_bf16 v[128:131], v[176:179], v[96:99], v[240:243]
    ds_read_b64_tr_b16 v[144:145], v212 offset:16384
    v_mfma_f32_16x16x32_bf16 v[136:139], v[176:179], v[100:103], v[244:247]
    ds_read_b64_tr_b16 v[146:147], v212 offset:20480
    v_mfma_f32_16x16x32_bf16 v[128:131], v[180:183], v[104:107], v[128:131]
    ds_read_b64_tr_b16 v[148:149], v213 offset:16384
    v_mfma_f32_16x16x32_bf16 v[136:139], v[180:183], v[108:111], v[136:139]
    ds_read_b64_tr_b16 v[150:151], v213 offset:20480
    v_mfma_f32_16x16x32_bf16 v[128:131], v[184:187], v[112:115], v[128:131]
    ds_read_b64_tr_b16 v[152:153], v214 offset:16384
    v_mfma_f32_16x16x32_bf16 v[136:139], v[184:187], v[116:119], v[136:139]
    ds_read_b64_tr_b16 v[154:155], v214 offset:20480
    v_mfma_f32_16x16x32_bf16 v[128:131], v[188:191], v[120:123], v[128:131]
    ds_read_b64_tr_b16 v[156:157], v215 offset:16384
    v_mfma_f32_16x16x32_bf16 v[136:139], v[188:191], v[124:127], v[136:139]
    ds_read_b64_tr_b16 v[158:159], v215 offset:20480
    v_mfma_f32_16x16x32_bf16 v[132:135], v[192:195], v[96:99], v[240:243]
    s_setprio 1
    ds_read_b64_tr_b16 v[168:169], v216 offset:16384
    v_mfma_f32_16x16x32_bf16 v[140:143], v[192:195], v[100:103], v[244:247]
    ds_read_b64_tr_b16 v[170:171], v216 offset:20480
    v_mfma_f32_16x16x32_bf16 v[132:135], v[196:199], v[104:107], v[132:135]
    ds_read_b64_tr_b16 v[172:173], v217 offset:16384
    v_mfma_f32_16x16x32_bf16 v[140:143], v[196:199], v[108:111], v[140:143]
    ds_read_b64_tr_b16 v[174:175], v217 offset:20480
    v_mfma_f32_16x16x32_bf16 v[132:135], v[200:203], v[112:115], v[132:135]
    ds_read_b64_tr_b16 v[176:177], v218 offset:16384
    v_mfma_f32_16x16x32_bf16 v[140:143], v[200:203], v[116:119], v[140:143]
    ds_read_b64_tr_b16 v[178:179], v218 offset:20480
    v_mfma_f32_16x16x32_bf16 v[132:135], v[204:207], v[120:123], v[132:135]
    ds_read_b64_tr_b16 v[180:181], v219 offset:16384
    v_mfma_f32_16x16x32_bf16 v[140:143], v[204:207], v[124:127], v[140:143]
    ds_read_b64_tr_b16 v[182:183], v219 offset:20480
    v_mfma_f32_16x16x32_bf16 v[226:229], v[248:251], v[160:163], v[226:229]
    v_mfma_f32_16x16x32_bf16 v[252:255], v[248:251], v[164:167], v[252:255]
    s_waitcnt lgkmcnt(14)
    v_mfma_f32_16x16x32_bf16 v[0:3], v[144:147], v[160:163], v[0:3]
    v_mfma_f32_16x16x32_bf16 v[4:7], v[144:147], v[164:167], v[4:7]
    s_waitcnt lgkmcnt(12)
    v_mfma_f32_16x16x32_bf16 v[8:11], v[148:151], v[160:163], v[8:11]
    v_mfma_f32_16x16x32_bf16 v[12:15], v[148:151], v[164:167], v[12:15]
    ds_read_b128 v[184:187], v210 offset:32768
    s_waitcnt lgkmcnt(11)
    v_mfma_f32_16x16x32_bf16 v[16:19], v[152:155], v[160:163], v[16:19]
    v_mfma_f32_16x16x32_bf16 v[20:23], v[152:155], v[164:167], v[20:23]
    ds_read_b128 v[188:191], v211 offset:32768
    s_waitcnt lgkmcnt(10)
    v_mfma_f32_16x16x32_bf16 v[24:27], v[156:159], v[160:163], v[24:27]
    v_mfma_f32_16x16x32_bf16 v[28:31], v[156:159], v[164:167], v[28:31]
    ds_read_b128 v[192:195], v208 offset:36864
    s_waitcnt lgkmcnt(9)
    v_mfma_f32_16x16x32_bf16 v[32:35], v[168:171], v[160:163], v[32:35]
    v_mfma_f32_16x16x32_bf16 v[36:39], v[168:171], v[164:167], v[36:39]
    ds_read_b128 v[196:199], v209 offset:36864
    s_waitcnt lgkmcnt(8)
    v_mfma_f32_16x16x32_bf16 v[40:43], v[172:175], v[160:163], v[40:43]
    v_mfma_f32_16x16x32_bf16 v[44:47], v[172:175], v[164:167], v[44:47]
    ds_read_b128 v[200:203], v210 offset:36864
    s_waitcnt lgkmcnt(7)
    v_mfma_f32_16x16x32_bf16 v[48:51], v[176:179], v[160:163], v[48:51]
    v_mfma_f32_16x16x32_bf16 v[52:55], v[176:179], v[164:167], v[52:55]
    ds_read_b128 v[204:207], v211 offset:36864
    s_waitcnt lgkmcnt(6)
    v_mfma_f32_16x16x32_bf16 v[56:59], v[180:183], v[160:163], v[56:59]
    v_mfma_f32_16x16x32_bf16 v[60:63], v[180:183], v[164:167], v[60:63]
    s_setprio 3
    v_exp_f32 v128, v128
    v_exp_f32 v129, v129
    v_exp_f32 v130, v130
    v_exp_f32 v131, v131
    v_exp_f32 v132, v132
    v_exp_f32 v133, v133
    buffer_store_dwordx4 v[84:87], v238, s[24:27], 0 offen offset:384 sc0 sc1
    v_cvt_pk_bf16_f32 v160, v128, v129
    v_cvt_pk_bf16_f32 v161, v130, v131
    v_exp_f32 v134, v134
    v_exp_f32 v135, v135
    v_exp_f32 v136, v136
    v_exp_f32 v137, v137
    v_cvt_pk_bf16_f32 v162, v132, v133
    v_cvt_pk_bf16_f32 v163, v134, v135
    ds_read_b128 v[176:179], v208 offset:32768
    v_exp_f32 v138, v138
    v_exp_f32 v139, v139
    v_exp_f32 v140, v140
    v_exp_f32 v141, v141
    v_cvt_pk_bf16_f32 v164, v136, v137
    v_cvt_pk_bf16_f32 v165, v138, v139
    ds_read_b128 v[180:183], v209 offset:32768
    v_exp_f32 v142, v142
    v_exp_f32 v143, v143
    v_cvt_pk_bf16_f32 v166, v140, v141
    v_cvt_pk_bf16_f32 v167, v142, v143
    v_permlane16_swap_b32 v92, v94
    v_permlane16_swap_b32 v93, v95
    v_subrev_u32 v208, 40960, v208
    v_subrev_u32 v209, 40960, v209
    v_subrev_u32 v210, 40960, v210
    v_subrev_u32 v211, 40960, v211
    s_waitcnt lgkmcnt(0)
    s_setprio 0
    v_mfma_f32_16x16x32_bf16 v[128:131], v[176:179], v[96:99], v[240:243]
    ds_read_b64_tr_b16 v[144:145], v212 offset:24576
    v_mfma_f32_16x16x32_bf16 v[136:139], v[176:179], v[100:103], v[244:247]
    ds_read_b64_tr_b16 v[146:147], v212 offset:28672
    v_mfma_f32_16x16x32_bf16 v[128:131], v[180:183], v[104:107], v[128:131]
    ds_read_b64_tr_b16 v[148:149], v213 offset:24576
    v_mfma_f32_16x16x32_bf16 v[136:139], v[180:183], v[108:111], v[136:139]
    ds_read_b64_tr_b16 v[150:151], v213 offset:28672
    v_mfma_f32_16x16x32_bf16 v[128:131], v[184:187], v[112:115], v[128:131]
    ds_read_b64_tr_b16 v[152:153], v214 offset:24576
    v_mfma_f32_16x16x32_bf16 v[136:139], v[184:187], v[116:119], v[136:139]
    ds_read_b64_tr_b16 v[154:155], v214 offset:28672
    v_mfma_f32_16x16x32_bf16 v[128:131], v[188:191], v[120:123], v[128:131]
    ds_read_b64_tr_b16 v[156:157], v215 offset:24576
    v_mfma_f32_16x16x32_bf16 v[136:139], v[188:191], v[124:127], v[136:139]
    ds_read_b64_tr_b16 v[158:159], v215 offset:28672
    v_mfma_f32_16x16x32_bf16 v[132:135], v[192:195], v[96:99], v[240:243]
    s_setprio 1
    ds_read_b64_tr_b16 v[168:169], v216 offset:24576
    v_mfma_f32_16x16x32_bf16 v[140:143], v[192:195], v[100:103], v[244:247]
    ds_read_b64_tr_b16 v[170:171], v216 offset:28672
    v_mfma_f32_16x16x32_bf16 v[132:135], v[196:199], v[104:107], v[132:135]
    ds_read_b64_tr_b16 v[172:173], v217 offset:24576
    v_mfma_f32_16x16x32_bf16 v[140:143], v[196:199], v[108:111], v[140:143]
    ds_read_b64_tr_b16 v[174:175], v217 offset:28672
    v_mfma_f32_16x16x32_bf16 v[132:135], v[200:203], v[112:115], v[132:135]
    ds_read_b64_tr_b16 v[176:177], v218 offset:24576
    v_mfma_f32_16x16x32_bf16 v[140:143], v[200:203], v[116:119], v[140:143]
    ds_read_b64_tr_b16 v[178:179], v218 offset:28672
    v_mfma_f32_16x16x32_bf16 v[132:135], v[204:207], v[120:123], v[132:135]
    ds_read_b64_tr_b16 v[180:181], v219 offset:24576
    v_mfma_f32_16x16x32_bf16 v[140:143], v[204:207], v[124:127], v[140:143]
    ds_read_b64_tr_b16 v[182:183], v219 offset:28672
    v_mfma_f32_16x16x32_bf16 v[226:229], v[248:251], v[160:163], v[226:229]
    v_mfma_f32_16x16x32_bf16 v[252:255], v[248:251], v[164:167], v[252:255]
    s_waitcnt lgkmcnt(14)
    v_mfma_f32_16x16x32_bf16 v[0:3], v[144:147], v[160:163], v[0:3]
    v_mfma_f32_16x16x32_bf16 v[4:7], v[144:147], v[164:167], v[4:7]
    s_waitcnt lgkmcnt(12)
    v_mfma_f32_16x16x32_bf16 v[8:11], v[148:151], v[160:163], v[8:11]
    v_mfma_f32_16x16x32_bf16 v[12:15], v[148:151], v[164:167], v[12:15]
    ds_read_b128 v[184:187], v210 offset:0
    s_waitcnt lgkmcnt(11)
    v_mfma_f32_16x16x32_bf16 v[16:19], v[152:155], v[160:163], v[16:19]
    v_mfma_f32_16x16x32_bf16 v[20:23], v[152:155], v[164:167], v[20:23]
    ds_read_b128 v[188:191], v211 offset:0
    s_waitcnt lgkmcnt(10)
    v_mfma_f32_16x16x32_bf16 v[24:27], v[156:159], v[160:163], v[24:27]
    v_mfma_f32_16x16x32_bf16 v[28:31], v[156:159], v[164:167], v[28:31]
    ds_read_b128 v[192:195], v208 offset:4096
    s_waitcnt lgkmcnt(9)
    v_mfma_f32_16x16x32_bf16 v[32:35], v[168:171], v[160:163], v[32:35]
    v_mfma_f32_16x16x32_bf16 v[36:39], v[168:171], v[164:167], v[36:39]
    ds_read_b128 v[196:199], v209 offset:4096
    s_waitcnt lgkmcnt(8)
    v_mfma_f32_16x16x32_bf16 v[40:43], v[172:175], v[160:163], v[40:43]
    v_mfma_f32_16x16x32_bf16 v[44:47], v[172:175], v[164:167], v[44:47]
    ds_read_b128 v[200:203], v210 offset:4096
    s_waitcnt lgkmcnt(7)
    v_mfma_f32_16x16x32_bf16 v[48:51], v[176:179], v[160:163], v[48:51]
    v_mfma_f32_16x16x32_bf16 v[52:55], v[176:179], v[164:167], v[52:55]
    ds_read_b128 v[204:207], v211 offset:4096
    s_waitcnt lgkmcnt(6)
    v_mfma_f32_16x16x32_bf16 v[56:59], v[180:183], v[160:163], v[56:59]
    v_mfma_f32_16x16x32_bf16 v[60:63], v[180:183], v[164:167], v[60:63]
    s_setprio 3
    v_exp_f32 v128, v128
    v_exp_f32 v129, v129
    v_exp_f32 v130, v130
    v_exp_f32 v131, v131
    v_exp_f32 v132, v132
    v_exp_f32 v133, v133
    buffer_store_dwordx4 v[92:95], v238, s[24:27], 0 offen offset:448 sc0 sc1
    v_cvt_pk_bf16_f32 v160, v128, v129
    v_cvt_pk_bf16_f32 v161, v130, v131
    v_exp_f32 v134, v134
    v_exp_f32 v135, v135
    v_exp_f32 v136, v136
    v_exp_f32 v137, v137
    v_cvt_pk_bf16_f32 v162, v132, v133
    v_cvt_pk_bf16_f32 v163, v134, v135
    ds_read_b128 v[176:179], v208 offset:0
    v_exp_f32 v138, v138
    v_exp_f32 v139, v139
    v_exp_f32 v140, v140
    v_exp_f32 v141, v141
    v_cvt_pk_bf16_f32 v164, v136, v137
    v_cvt_pk_bf16_f32 v165, v138, v139
    ds_read_b128 v[180:183], v209 offset:0
    v_exp_f32 v142, v142
    v_exp_f32 v143, v143
    v_cvt_pk_bf16_f32 v166, v140, v141
    v_cvt_pk_bf16_f32 v167, v142, v143
    s_cbranch_vccnz L_g47
    s_waitcnt vmcnt(3)
    s_barrier
L_g47:
    s_waitcnt lgkmcnt(0)
    s_setprio 0
    v_mfma_f32_16x16x32_bf16 v[128:131], v[176:179], v[96:99], v[240:243]
    ds_read_b64_tr_b16 v[144:145], v212 offset:32768
    v_mfma_f32_16x16x32_bf16 v[136:139], v[176:179], v[100:103], v[244:247]
    ds_read_b64_tr_b16 v[146:147], v212 offset:36864
    v_mfma_f32_16x16x32_bf16 v[128:131], v[180:183], v[104:107], v[128:131]
    ds_read_b64_tr_b16 v[148:149], v213 offset:32768
    v_mfma_f32_16x16x32_bf16 v[136:139], v[180:183], v[108:111], v[136:139]
    ds_read_b64_tr_b16 v[150:151], v213 offset:36864
    v_mfma_f32_16x16x32_bf16 v[128:131], v[184:187], v[112:115], v[128:131]
    ds_read_b64_tr_b16 v[152:153], v214 offset:32768
    v_mfma_f32_16x16x32_bf16 v[136:139], v[184:187], v[116:119], v[136:139]
    ds_read_b64_tr_b16 v[154:155], v214 offset:36864
    v_mfma_f32_16x16x32_bf16 v[128:131], v[188:191], v[120:123], v[128:131]
    ds_read_b64_tr_b16 v[156:157], v215 offset:32768
    v_mfma_f32_16x16x32_bf16 v[136:139], v[188:191], v[124:127], v[136:139]
    ds_read_b64_tr_b16 v[158:159], v215 offset:36864
    v_mfma_f32_16x16x32_bf16 v[132:135], v[192:195], v[96:99], v[240:243]
    s_setprio 1
    ds_read_b64_tr_b16 v[168:169], v216 offset:32768
    v_mfma_f32_16x16x32_bf16 v[140:143], v[192:195], v[100:103], v[244:247]
    ds_read_b64_tr_b16 v[170:171], v216 offset:36864
    v_mfma_f32_16x16x32_bf16 v[132:135], v[196:199], v[104:107], v[132:135]
    ds_read_b64_tr_b16 v[172:173], v217 offset:32768
    v_mfma_f32_16x16x32_bf16 v[140:143], v[196:199], v[108:111], v[140:143]
    ds_read_b64_tr_b16 v[174:175], v217 offset:36864
    v_mfma_f32_16x16x32_bf16 v[132:135], v[200:203], v[112:115], v[132:135]
    ds_read_b64_tr_b16 v[176:177], v218 offset:32768
    v_mfma_f32_16x16x32_bf16 v[140:143], v[200:203], v[116:119], v[140:143]
    ds_read_b64_tr_b16 v[178:179], v218 offset:36864
    v_mfma_f32_16x16x32_bf16 v[132:135], v[204:207], v[120:123], v[132:135]
    ds_read_b64_tr_b16 v[180:181], v219 offset:32768
    v_mfma_f32_16x16x32_bf16 v[140:143], v[204:207], v[124:127], v[140:143]
    ds_read_b64_tr_b16 v[182:183], v219 offset:36864
    v_mfma_f32_16x16x32_bf16 v[226:229], v[248:251], v[160:163], v[226:229]
    v_mfma_f32_16x16x32_bf16 v[252:255], v[248:251], v[164:167], v[252:255]
    s_waitcnt lgkmcnt(14)
    v_mfma_f32_16x16x32_bf16 v[0:3], v[144:147], v[160:163], v[0:3]
    v_mfma_f32_16x16x32_bf16 v[4:7], v[144:147], v[164:167], v[4:7]
    s_waitcnt lgkmcnt(12)
    v_mfma_f32_16x16x32_bf16 v[8:11], v[148:151], v[160:163], v[8:11]
    v_mfma_f32_16x16x32_bf16 v[12:15], v[148:151], v[164:167], v[12:15]
    ds_read_b128 v[184:187], v210 offset:8192
    s_waitcnt lgkmcnt(11)
    v_mfma_f32_16x16x32_bf16 v[16:19], v[152:155], v[160:163], v[16:19]
    v_mfma_f32_16x16x32_bf16 v[20:23], v[152:155], v[164:167], v[20:23]
    ds_read_b128 v[188:191], v211 offset:8192
    s_waitcnt lgkmcnt(10)
    v_mfma_f32_16x16x32_bf16 v[24:27], v[156:159], v[160:163], v[24:27]
    v_mfma_f32_16x16x32_bf16 v[28:31], v[156:159], v[164:167], v[28:31]
    ds_read_b128 v[192:195], v208 offset:12288
    s_waitcnt lgkmcnt(9)
    v_mfma_f32_16x16x32_bf16 v[32:35], v[168:171], v[160:163], v[32:35]
    v_mfma_f32_16x16x32_bf16 v[36:39], v[168:171], v[164:167], v[36:39]
    ds_read_b128 v[196:199], v209 offset:12288
    s_waitcnt lgkmcnt(8)
    v_mfma_f32_16x16x32_bf16 v[40:43], v[172:175], v[160:163], v[40:43]
    v_mfma_f32_16x16x32_bf16 v[44:47], v[172:175], v[164:167], v[44:47]
    ds_read_b128 v[200:203], v210 offset:12288
    s_waitcnt lgkmcnt(7)
    v_mfma_f32_16x16x32_bf16 v[48:51], v[176:179], v[160:163], v[48:51]
    v_mfma_f32_16x16x32_bf16 v[52:55], v[176:179], v[164:167], v[52:55]
    ds_read_b128 v[204:207], v211 offset:12288
    s_waitcnt lgkmcnt(6)
    v_mfma_f32_16x16x32_bf16 v[56:59], v[180:183], v[160:163], v[56:59]
    v_mfma_f32_16x16x32_bf16 v[60:63], v[180:183], v[164:167], v[60:63]
    s_setprio 3
    v_subrev_u32 v212, 40960, v212
    v_subrev_u32 v213, 40960, v213
    v_subrev_u32 v214, 40960, v214
    v_subrev_u32 v215, 40960, v215
    v_subrev_u32 v216, 40960, v216
    v_subrev_u32 v217, 40960, v217
    v_subrev_u32 v218, 40960, v218
    v_subrev_u32 v219, 40960, v219
    v_exp_f32 v128, v128
    v_exp_f32 v129, v129
    v_exp_f32 v130, v130
    v_exp_f32 v131, v131
    v_exp_f32 v132, v132
    v_exp_f32 v133, v133
    v_cvt_pk_bf16_f32 v160, v128, v129
    v_cvt_pk_bf16_f32 v161, v130, v131
    v_exp_f32 v134, v134
    v_exp_f32 v135, v135
    ds_read_b128 v[176:179], v208 offset:8192
    v_exp_f32 v136, v136
    v_exp_f32 v137, v137
    v_cvt_pk_bf16_f32 v162, v132, v133
    v_cvt_pk_bf16_f32 v163, v134, v135
    v_exp_f32 v138, v138
    v_exp_f32 v139, v139
    v_exp_f32 v140, v140
    v_exp_f32 v141, v141
    v_cvt_pk_bf16_f32 v164, v136, v137
    v_cvt_pk_bf16_f32 v165, v138, v139
    ds_read_b128 v[180:183], v209 offset:8192
    v_exp_f32 v142, v142
    v_exp_f32 v143, v143
    v_cvt_pk_bf16_f32 v166, v140, v141
    v_cvt_pk_bf16_f32 v167, v142, v143
    s_waitcnt lgkmcnt(0)
    s_setprio 0
    v_mfma_f32_16x16x32_bf16 v[128:131], v[176:179], v[96:99], v[240:243]
    ds_read_b64_tr_b16 v[144:145], v212 offset:0
    v_mfma_f32_16x16x32_bf16 v[136:139], v[176:179], v[100:103], v[244:247]
    ds_read_b64_tr_b16 v[146:147], v212 offset:4096
    v_mfma_f32_16x16x32_bf16 v[128:131], v[180:183], v[104:107], v[128:131]
    ds_read_b64_tr_b16 v[148:149], v213 offset:0
    v_mfma_f32_16x16x32_bf16 v[136:139], v[180:183], v[108:111], v[136:139]
    ds_read_b64_tr_b16 v[150:151], v213 offset:4096
    v_mfma_f32_16x16x32_bf16 v[128:131], v[184:187], v[112:115], v[128:131]
    ds_read_b64_tr_b16 v[152:153], v214 offset:0
    v_mfma_f32_16x16x32_bf16 v[136:139], v[184:187], v[116:119], v[136:139]
    ds_read_b64_tr_b16 v[154:155], v214 offset:4096
    v_mfma_f32_16x16x32_bf16 v[128:131], v[188:191], v[120:123], v[128:131]
    ds_read_b64_tr_b16 v[156:157], v215 offset:0
    v_mfma_f32_16x16x32_bf16 v[136:139], v[188:191], v[124:127], v[136:139]
    ds_read_b64_tr_b16 v[158:159], v215 offset:4096
    v_mfma_f32_16x16x32_bf16 v[132:135], v[192:195], v[96:99], v[240:243]
    s_setprio 1
    ds_read_b64_tr_b16 v[168:169], v216 offset:0
    v_mfma_f32_16x16x32_bf16 v[140:143], v[192:195], v[100:103], v[244:247]
    ds_read_b64_tr_b16 v[170:171], v216 offset:4096
    v_mfma_f32_16x16x32_bf16 v[132:135], v[196:199], v[104:107], v[132:135]
    ds_read_b64_tr_b16 v[172:173], v217 offset:0
    v_mfma_f32_16x16x32_bf16 v[140:143], v[196:199], v[108:111], v[140:143]
    ds_read_b64_tr_b16 v[174:175], v217 offset:4096
    v_mfma_f32_16x16x32_bf16 v[132:135], v[200:203], v[112:115], v[132:135]
    ds_read_b64_tr_b16 v[176:177], v218 offset:0
    v_mfma_f32_16x16x32_bf16 v[140:143], v[200:203], v[116:119], v[140:143]
    ds_read_b64_tr_b16 v[178:179], v218 offset:4096
    v_mfma_f32_16x16x32_bf16 v[132:135], v[204:207], v[120:123], v[132:135]
    ds_read_b64_tr_b16 v[180:181], v219 offset:0
    v_mfma_f32_16x16x32_bf16 v[140:143], v[204:207], v[124:127], v[140:143]
    ds_read_b64_tr_b16 v[182:183], v219 offset:4096
    v_mfma_f32_16x16x32_bf16 v[226:229], v[248:251], v[160:163], v[226:229]
    v_mfma_f32_16x16x32_bf16 v[252:255], v[248:251], v[164:167], v[252:255]
    s_waitcnt lgkmcnt(14)
    v_mfma_f32_16x16x32_bf16 v[0:3], v[144:147], v[160:163], v[0:3]
    v_mfma_f32_16x16x32_bf16 v[4:7], v[144:147], v[164:167], v[4:7]
    s_waitcnt lgkmcnt(12)
    v_mfma_f32_16x16x32_bf16 v[8:11], v[148:151], v[160:163], v[8:11]
    v_mfma_f32_16x16x32_bf16 v[12:15], v[148:151], v[164:167], v[12:15]
    s_waitcnt lgkmcnt(10)
    v_mfma_f32_16x16x32_bf16 v[16:19], v[152:155], v[160:163], v[16:19]
    v_mfma_f32_16x16x32_bf16 v[20:23], v[152:155], v[164:167], v[20:23]
    s_waitcnt lgkmcnt(8)
    v_mfma_f32_16x16x32_bf16 v[24:27], v[156:159], v[160:163], v[24:27]
    v_mfma_f32_16x16x32_bf16 v[28:31], v[156:159], v[164:167], v[28:31]
    s_waitcnt lgkmcnt(6)
    v_mfma_f32_16x16x32_bf16 v[32:35], v[168:171], v[160:163], v[32:35]
    v_mfma_f32_16x16x32_bf16 v[36:39], v[168:171], v[164:167], v[36:39]
    s_waitcnt lgkmcnt(4)
    v_mfma_f32_16x16x32_bf16 v[40:43], v[172:175], v[160:163], v[40:43]
    v_mfma_f32_16x16x32_bf16 v[44:47], v[172:175], v[164:167], v[44:47]
    s_waitcnt lgkmcnt(2)
    v_mfma_f32_16x16x32_bf16 v[48:51], v[176:179], v[160:163], v[48:51]
    v_mfma_f32_16x16x32_bf16 v[52:55], v[176:179], v[164:167], v[52:55]
    s_waitcnt lgkmcnt(0)
    v_mfma_f32_16x16x32_bf16 v[56:59], v[180:183], v[160:163], v[56:59]
    v_mfma_f32_16x16x32_bf16 v[60:63], v[180:183], v[164:167], v[60:63]
    s_setprio 3
    v_exp_f32 v128, v128
    v_exp_f32 v129, v129
    ds_read_b64_tr_b16 v[144:145], v212 offset:8192
    v_exp_f32 v130, v130
    ds_read_b64_tr_b16 v[146:147], v212 offset:12288
    v_exp_f32 v131, v131
    ds_read_b64_tr_b16 v[148:149], v213 offset:8192
    v_exp_f32 v132, v132
    ds_read_b64_tr_b16 v[150:151], v213 offset:12288
    v_exp_f32 v133, v133
    ds_read_b64_tr_b16 v[152:153], v214 offset:8192
    v_cvt_pk_bf16_f32 v160, v128, v129
    v_cvt_pk_bf16_f32 v161, v130, v131
    ds_read_b64_tr_b16 v[154:155], v214 offset:12288
    v_exp_f32 v134, v134
    ds_read_b64_tr_b16 v[156:157], v215 offset:8192
    v_exp_f32 v135, v135
    ds_read_b64_tr_b16 v[158:159], v215 offset:12288
    v_exp_f32 v136, v136
    ds_read_b64_tr_b16 v[168:169], v216 offset:8192
    v_exp_f32 v137, v137
    ds_read_b64_tr_b16 v[170:171], v216 offset:12288
    v_cvt_pk_bf16_f32 v162, v132, v133
    v_cvt_pk_bf16_f32 v163, v134, v135
    ds_read_b64_tr_b16 v[172:173], v217 offset:8192
    v_exp_f32 v138, v138
    ds_read_b64_tr_b16 v[174:175], v217 offset:12288
    v_exp_f32 v139, v139
    ds_read_b64_tr_b16 v[176:177], v218 offset:8192
    v_exp_f32 v140, v140
    ds_read_b64_tr_b16 v[178:179], v218 offset:12288
    v_exp_f32 v141, v141
    ds_read_b64_tr_b16 v[180:181], v219 offset:8192
    v_cvt_pk_bf16_f32 v164, v136, v137
    v_cvt_pk_bf16_f32 v165, v138, v139
    ds_read_b64_tr_b16 v[182:183], v219 offset:12288
    v_exp_f32 v142, v142
    v_exp_f32 v143, v143
    v_cvt_pk_bf16_f32 v166, v140, v141
    v_cvt_pk_bf16_f32 v167, v142, v143
    s_waitcnt lgkmcnt(0)
    s_setprio 0
    v_mfma_f32_16x16x32_bf16 v[226:229], v[248:251], v[160:163], v[226:229]
    v_mfma_f32_16x16x32_bf16 v[252:255], v[248:251], v[164:167], v[252:255]
    v_mfma_f32_16x16x32_bf16 v[0:3], v[144:147], v[160:163], v[0:3]
    v_mfma_f32_16x16x32_bf16 v[4:7], v[144:147], v[164:167], v[4:7]
    v_mfma_f32_16x16x32_bf16 v[8:11], v[148:151], v[160:163], v[8:11]
    v_mfma_f32_16x16x32_bf16 v[12:15], v[148:151], v[164:167], v[12:15]
    s_nop 2
    v_rcp_f32 v230, v226
    v_rcp_f32 v232, v252
    v_mov_b32 v231, 0x4e800000
    v_add_f32 v233, v226, v252
    v_add_f32 v233, v233, v230
    v_add_f32 v233, v233, v232
    v_cmp_nlt_f32 s[38:39], v233, v231
    v_mfma_f32_16x16x32_bf16 v[16:19], v[152:155], v[160:163], v[16:19]
    v_mfma_f32_16x16x32_bf16 v[20:23], v[152:155], v[164:167], v[20:23]
    v_mfma_f32_16x16x32_bf16 v[24:27], v[156:159], v[160:163], v[24:27]
    v_mfma_f32_16x16x32_bf16 v[28:31], v[156:159], v[164:167], v[28:31]
    v_pk_mul_f32 v[0:1], v[0:1], v[230:231] op_sel_hi:[1,0]
    v_pk_mul_f32 v[2:3], v[2:3], v[230:231] op_sel_hi:[1,0]
    v_cvt_pk_bf16_f32 v96, v0, v1
    v_pk_mul_f32 v[4:5], v[4:5], v[232:233] op_sel_hi:[1,0]
    v_cvt_pk_bf16_f32 v97, v2, v3
    v_pk_mul_f32 v[6:7], v[6:7], v[232:233] op_sel_hi:[1,0]
    v_cvt_pk_bf16_f32 v100, v4, v5
    v_pk_mul_f32 v[8:9], v[8:9], v[230:231] op_sel_hi:[1,0]
    v_cvt_pk_bf16_f32 v101, v6, v7
    v_pk_mul_f32 v[10:11], v[10:11], v[230:231] op_sel_hi:[1,0]
    v_cvt_pk_bf16_f32 v98, v8, v9
    v_pk_mul_f32 v[12:13], v[12:13], v[232:233] op_sel_hi:[1,0]
    v_cvt_pk_bf16_f32 v99, v10, v11
    v_pk_mul_f32 v[14:15], v[14:15], v[232:233] op_sel_hi:[1,0]
    v_cvt_pk_bf16_f32 v102, v12, v13
    v_cvt_pk_bf16_f32 v103, v14, v15
    v_permlane16_swap_b32 v96, v98
    v_permlane16_swap_b32 v97, v99
    ds_bpermute_b32 v96, v225, v96
    ds_bpermute_b32 v97, v225, v97
    ds_bpermute_b32 v98, v225, v98
    ds_bpermute_b32 v99, v225, v99
    v_permlane16_swap_b32 v100, v102
    v_permlane16_swap_b32 v101, v103
    ds_bpermute_b32 v100, v225, v100
    ds_bpermute_b32 v101, v225, v101
    ds_bpermute_b32 v102, v225, v102
    ds_bpermute_b32 v103, v225, v103
    v_mfma_f32_16x16x32_bf16 v[32:35], v[168:171], v[160:163], v[32:35]
    v_mfma_f32_16x16x32_bf16 v[36:39], v[168:171], v[164:167], v[36:39]
    v_mfma_f32_16x16x32_bf16 v[40:43], v[172:175], v[160:163], v[40:43]
    v_mfma_f32_16x16x32_bf16 v[44:47], v[172:175], v[164:167], v[44:47]
    v_pk_mul_f32 v[16:17], v[16:17], v[230:231] op_sel_hi:[1,0]
    v_pk_mul_f32 v[18:19], v[18:19], v[230:231] op_sel_hi:[1,0]
    v_cvt_pk_bf16_f32 v104, v16, v17
    v_pk_mul_f32 v[20:21], v[20:21], v[232:233] op_sel_hi:[1,0]
    v_cvt_pk_bf16_f32 v105, v18, v19
    v_pk_mul_f32 v[22:23], v[22:23], v[232:233] op_sel_hi:[1,0]
    v_cvt_pk_bf16_f32 v108, v20, v21
    v_pk_mul_f32 v[24:25], v[24:25], v[230:231] op_sel_hi:[1,0]
    v_cvt_pk_bf16_f32 v109, v22, v23
    v_pk_mul_f32 v[26:27], v[26:27], v[230:231] op_sel_hi:[1,0]
    v_cvt_pk_bf16_f32 v106, v24, v25
    v_pk_mul_f32 v[28:29], v[28:29], v[232:233] op_sel_hi:[1,0]
    v_cvt_pk_bf16_f32 v107, v26, v27
    v_pk_mul_f32 v[30:31], v[30:31], v[232:233] op_sel_hi:[1,0]
    v_cvt_pk_bf16_f32 v110, v28, v29
    v_cvt_pk_bf16_f32 v111, v30, v31
    s_waitcnt lgkmcnt(4)
    buffer_store_dwordx4 v[96:99], v223, s[28:31], 0 offen offset:0 sc0 sc1
    s_waitcnt lgkmcnt(0)
    buffer_store_dwordx4 v[100:103], v223, s[28:31], 0 offen offset:256 sc0 sc1
    v_permlane16_swap_b32 v104, v106
    v_permlane16_swap_b32 v105, v107
    ds_bpermute_b32 v104, v225, v104
    ds_bpermute_b32 v105, v225, v105
    ds_bpermute_b32 v106, v225, v106
    ds_bpermute_b32 v107, v225, v107
    v_permlane16_swap_b32 v108, v110
    v_permlane16_swap_b32 v109, v111
    ds_bpermute_b32 v108, v225, v108
    ds_bpermute_b32 v109, v225, v109
    ds_bpermute_b32 v110, v225, v110
    ds_bpermute_b32 v111, v225, v111
    v_mfma_f32_16x16x32_bf16 v[48:51], v[176:179], v[160:163], v[48:51]
    v_mfma_f32_16x16x32_bf16 v[52:55], v[176:179], v[164:167], v[52:55]
    v_mfma_f32_16x16x32_bf16 v[56:59], v[180:183], v[160:163], v[56:59]
    v_mfma_f32_16x16x32_bf16 v[60:63], v[180:183], v[164:167], v[60:63]
    v_pk_mul_f32 v[32:33], v[32:33], v[230:231] op_sel_hi:[1,0]
    v_pk_mul_f32 v[34:35], v[34:35], v[230:231] op_sel_hi:[1,0]
    v_cvt_pk_bf16_f32 v112, v32, v33
    v_pk_mul_f32 v[36:37], v[36:37], v[232:233] op_sel_hi:[1,0]
    v_cvt_pk_bf16_f32 v113, v34, v35
    v_pk_mul_f32 v[38:39], v[38:39], v[232:233] op_sel_hi:[1,0]
    v_cvt_pk_bf16_f32 v116, v36, v37
    v_pk_mul_f32 v[40:41], v[40:41], v[230:231] op_sel_hi:[1,0]
    v_cvt_pk_bf16_f32 v117, v38, v39
    v_pk_mul_f32 v[42:43], v[42:43], v[230:231] op_sel_hi:[1,0]
    v_cvt_pk_bf16_f32 v114, v40, v41
    v_pk_mul_f32 v[44:45], v[44:45], v[232:233] op_sel_hi:[1,0]
    v_cvt_pk_bf16_f32 v115, v42, v43
    v_pk_mul_f32 v[46:47], v[46:47], v[232:233] op_sel_hi:[1,0]
    v_cvt_pk_bf16_f32 v118, v44, v45
    v_cvt_pk_bf16_f32 v119, v46, v47
    s_waitcnt lgkmcnt(4)
    buffer_store_dwordx4 v[104:107], v223, s[28:31], 0 offen offset:64 sc0 sc1
    s_waitcnt lgkmcnt(0)
    buffer_store_dwordx4 v[108:111], v223, s[28:31], 0 offen offset:320 sc0 sc1
    v_permlane16_swap_b32 v112, v114
    v_permlane16_swap_b32 v113, v115
    ds_bpermute_b32 v112, v225, v112
    ds_bpermute_b32 v113, v225, v113
    ds_bpermute_b32 v114, v225, v114
    ds_bpermute_b32 v115, v225, v115
    v_permlane16_swap_b32 v116, v118
    v_permlane16_swap_b32 v117, v119
    ds_bpermute_b32 v116, v225, v116
    ds_bpermute_b32 v117, v225, v117
    ds_bpermute_b32 v118, v225, v118
    ds_bpermute_b32 v119, v225, v119
    s_setprio 3
    v_pk_mul_f32 v[48:49], v[48:49], v[230:231] op_sel_hi:[1,0]
    v_pk_mul_f32 v[50:51], v[50:51], v[230:231] op_sel_hi:[1,0]
    v_cvt_pk_bf16_f32 v120, v48, v49
    v_pk_mul_f32 v[52:53], v[52:53], v[232:233] op_sel_hi:[1,0]
    v_cvt_pk_bf16_f32 v121, v50, v51
    v_pk_mul_f32 v[54:55], v[54:55], v[232:233] op_sel_hi:[1,0]
    v_cvt_pk_bf16_f32 v124, v52, v53
    v_pk_mul_f32 v[56:57], v[56:57], v[230:231] op_sel_hi:[1,0]
    v_cvt_pk_bf16_f32 v125, v54, v55
    v_pk_mul_f32 v[58:59], v[58:59], v[230:231] op_sel_hi:[1,0]
    v_cvt_pk_bf16_f32 v122, v56, v57
    v_pk_mul_f32 v[60:61], v[60:61], v[232:233] op_sel_hi:[1,0]
    v_cvt_pk_bf16_f32 v123, v58, v59
    v_pk_mul_f32 v[62:63], v[62:63], v[232:233] op_sel_hi:[1,0]
    v_cvt_pk_bf16_f32 v126, v60, v61
    v_cvt_pk_bf16_f32 v127, v62, v63
    s_waitcnt lgkmcnt(4)
    buffer_store_dwordx4 v[112:115], v223, s[28:31], 0 offen offset:128 sc0 sc1
    s_waitcnt lgkmcnt(0)
    buffer_store_dwordx4 v[116:119], v223, s[28:31], 0 offen offset:384 sc0 sc1
    v_permlane16_swap_b32 v120, v122
    v_permlane16_swap_b32 v121, v123
    ds_bpermute_b32 v120, v225, v120
    ds_bpermute_b32 v121, v225, v121
    ds_bpermute_b32 v122, v225, v122
    ds_bpermute_b32 v123, v225, v123
    v_permlane16_swap_b32 v124, v126
    v_permlane16_swap_b32 v125, v127
    ds_bpermute_b32 v124, v225, v124
    ds_bpermute_b32 v125, v225, v125
    ds_bpermute_b32 v126, v225, v126
    ds_bpermute_b32 v127, v225, v127
    s_waitcnt lgkmcnt(4)
    buffer_store_dwordx4 v[120:123], v223, s[28:31], 0 offen offset:192 sc0 sc1
    s_waitcnt lgkmcnt(0)
    buffer_store_dwordx4 v[124:127], v223, s[28:31], 0 offen offset:448 sc0 sc1
    s_barrier
    s_or_b64 s[48:49], s[36:37], s[38:39]
    s_cbranch_scc0 L_end
    s_waitcnt vmcnt(0) lgkmcnt(0)
    s_nop 7
    s_nop 7
    s_lshl_b32 s48, s33, 3
    s_sub_u32 s49, s48, 0
    v_add_u32 v208, s49, v208
    v_add_u32 v209, s49, v209
    v_add_u32 v210, s49, v210
    v_add_u32 v211, s49, v211
    v_add_u32 v212, s49, v212
    v_add_u32 v213, s49, v213
    v_add_u32 v214, s49, v214
    v_add_u32 v215, s49, v215
    v_add_u32 v216, s49, v216
    v_add_u32 v217, s49, v217
    v_add_u32 v218, s49, v218
    v_add_u32 v219, s49, v219
    v_mov_b32 v248, 0x3f803f80
    v_mov_b32 v249, 0x3f803f80
    v_mov_b32 v250, 0x3f803f80
    v_mov_b32 v251, 0x3f803f80
    s_cmp_eq_u64 s[36:37], 0
    s_cbranch_scc1 L_sk0
    v_mbcnt_lo_u32_b32 v116, -1, 0
    v_mbcnt_hi_u32_b32 v116, -1, v116
    v_and_b32 v117, 15, v116
    v_lshrrev_b32 v116, 4, v116
    v_add_u32 v118, 0, v116
    v_and_b32 v119, 15, v118
    v_xor_b32 v119, v119, v117
    v_lshlrev_b32 v119, 4, v119
    v_lshl_add_u32 v96, v118, 8, v119
    v_and_b32 v119, 7, v118
    v_lshlrev_b32 v119, 1, v119
    v_xor_b32 v119, v119, v117
    v_lshlrev_b32 v119, 4, v119
    v_lshl_add_u32 v104, v118, 8, v119
    v_add_u32 v118, 4, v116
    v_and_b32 v119, 15, v118
    v_xor_b32 v119, v119, v117
    v_lshlrev_b32 v119, 4, v119
    v_lshl_add_u32 v97, v118, 8, v119
    v_and_b32 v119, 7, v118
    v_lshlrev_b32 v119, 1, v119
    v_xor_b32 v119, v119, v117
    v_lshlrev_b32 v119, 4, v119
    v_lshl_add_u32 v105, v118, 8, v119
    v_add_u32 v118, 8, v116
    v_and_b32 v119, 15, v118
    v_xor_b32 v119, v119, v117
    v_lshlrev_b32 v119, 4, v119
    v_lshl_add_u32 v98, v118, 8, v119
    v_and_b32 v119, 7, v118
    v_lshlrev_b32 v119, 1, v119
    v_xor_b32 v119, v119, v117
    v_lshlrev_b32 v119, 4, v119
    v_lshl_add_u32 v106, v118, 8, v119
    v_add_u32 v118, 12, v116
    v_and_b32 v119, 15, v118
    v_xor_b32 v119, v119, v117
    v_lshlrev_b32 v119, 4, v119
    v_lshl_add_u32 v99, v118, 8, v119
    v_and_b32 v119, 7, v118
    v_lshlrev_b32 v119, 1, v119
    v_xor_b32 v119, v119, v117
    v_lshlrev_b32 v119, 4, v119
    v_lshl_add_u32 v107, v118, 8, v119
    v_add_u32 v118, 16, v116
    v_and_b32 v119, 15, v118
    v_xor_b32 v119, v119, v117
    v_lshlrev_b32 v119, 4, v119
    v_lshl_add_u32 v100, v118, 8, v119
    v_and_b32 v119, 7, v118
    v_lshlrev_b32 v119, 1, v119
    v_xor_b32 v119, v119, v117
    v_lshlrev_b32 v119, 4, v119
    v_lshl_add_u32 v108, v118, 8, v119
    v_add_u32 v118, 20, v116
    v_and_b32 v119, 15, v118
    v_xor_b32 v119, v119, v117
    v_lshlrev_b32 v119, 4, v119
    v_lshl_add_u32 v101, v118, 8, v119
    v_and_b32 v119, 7, v118
    v_lshlrev_b32 v119, 1, v119
    v_xor_b32 v119, v119, v117
    v_lshlrev_b32 v119, 4, v119
    v_lshl_add_u32 v109, v118, 8, v119
    v_add_u32 v118, 24, v116
    v_and_b32 v119, 15, v118
    v_xor_b32 v119, v119, v117
    v_lshlrev_b32 v119, 4, v119
    v_lshl_add_u32 v102, v118, 8, v119
    v_and_b32 v119, 7, v118
    v_lshlrev_b32 v119, 1, v119
    v_xor_b32 v119, v119, v117
    v_lshlrev_b32 v119, 4, v119
    v_lshl_add_u32 v110, v118, 8, v119
    v_add_u32 v118, 28, v116
    v_and_b32 v119, 15, v118
    v_xor_b32 v119, v119, v117
    v_lshlrev_b32 v119, 4, v119
    v_lshl_add_u32 v103, v118, 8, v119
    v_and_b32 v119, 7, v118
    v_lshlrev_b32 v119, 1, v119
    v_xor_b32 v119, v119, v117
    v_lshlrev_b32 v119, 4, v119
    v_lshl_add_u32 v111, v118, 8, v119
    buffer_load_dwordx4 v[64:67], v222, s[8:11], 0 offen offset:0
    buffer_load_dwordx4 v[68:71], v222, s[8:11], 0 offen offset:256
    buffer_load_dwordx4 v[72:75], v222, s[8:11], 0 offen offset:64
    buffer_load_dwordx4 v[76:79], v222, s[8:11], 0 offen offset:320
    buffer_load_dwordx4 v[80:83], v222, s[8:11], 0 offen offset:128
    buffer_load_dwordx4 v[84:87], v222, s[8:11], 0 offen offset:384
    buffer_load_dwordx4 v[88:91], v222, s[8:11], 0 offen offset:192
    buffer_load_dwordx4 v[92:95], v222, s[8:11], 0 offen offset:448
    s_waitcnt vmcnt(7)
    ds_bpermute_b32 v64, v224, v64
    ds_bpermute_b32 v65, v224, v65
    ds_bpermute_b32 v66, v224, v66
    ds_bpermute_b32 v67, v224, v67
    s_waitcnt vmcnt(6)
    ds_bpermute_b32 v68, v224, v68
    ds_bpermute_b32 v69, v224, v69
    ds_bpermute_b32 v70, v224, v70
    ds_bpermute_b32 v71, v224, v71
    s_waitcnt vmcnt(5)
    ds_bpermute_b32 v72, v224, v72
    ds_bpermute_b32 v73, v224, v73
    ds_bpermute_b32 v74, v224, v74
    ds_bpermute_b32 v75, v224, v75
    s_waitcnt vmcnt(4)
    ds_bpermute_b32 v76, v224, v76
    ds_bpermute_b32 v77, v224, v77
    ds_bpermute_b32 v78, v224, v78
    ds_bpermute_b32 v79, v224, v79
    s_waitcnt vmcnt(3)
    ds_bpermute_b32 v80, v224, v80
    ds_bpermute_b32 v81, v224, v81
    ds_bpermute_b32 v82, v224, v82
    ds_bpermute_b32 v83, v224, v83
    s_waitcnt vmcnt(2)
    ds_bpermute_b32 v84, v224, v84
    ds_bpermute_b32 v85, v224, v85
    ds_bpermute_b32 v86, v224, v86
    ds_bpermute_b32 v87, v224, v87
    s_waitcnt vmcnt(1)
    ds_bpermute_b32 v88, v224, v88
    ds_bpermute_b32 v89, v224, v89
    ds_bpermute_b32 v90, v224, v90
    ds_bpermute_b32 v91, v224, v91
    s_waitcnt vmcnt(0)
    ds_bpermute_b32 v92, v224, v92
    ds_bpermute_b32 v93, v224, v93
    ds_bpermute_b32 v94, v224, v94
    ds_bpermute_b32 v95, v224, v95
    v_mov_b32 v0, 0
    v_mov_b32 v1, 0
    v_mov_b32 v2, 0
    v_mov_b32 v3, 0
    v_mov_b32 v4, 0
    v_mov_b32 v5, 0
    v_mov_b32 v6, 0
    v_mov_b32 v7, 0
    v_mov_b32 v8, 0
    v_mov_b32 v9, 0
    v_mov_b32 v10, 0
    v_mov_b32 v11, 0
    v_mov_b32 v12, 0
    v_mov_b32 v13, 0
    v_mov_b32 v14, 0
    v_mov_b32 v15, 0
    v_mov_b32 v16, 0
    v_mov_b32 v17, 0
    v_mov_b32 v18, 0
    v_mov_b32 v19, 0
    v_mov_b32 v20, 0
    v_mov_b32 v21, 0
    v_mov_b32 v22, 0
    v_mov_b32 v23, 0
    v_mov_b32 v24, 0
    v_mov_b32 v25, 0
    v_mov_b32 v26, 0
    v_mov_b32 v27, 0
    v_mov_b32 v28, 0
    v_mov_b32 v29, 0
    v_mov_b32 v30, 0
    v_mov_b32 v31, 0
    v_mov_b32 v32, 0
    v_mov_b32 v33, 0
    v_mov_b32 v34, 0
    v_mov_b32 v35, 0
    v_mov_b32 v36, 0
    v_mov_b32 v37, 0
    v_mov_b32 v38, 0
    v_mov_b32 v39, 0
    v_mov_b32 v40, 0
    v_mov_b32 v41, 0
    v_mov_b32 v42, 0
    v_mov_b32 v43, 0
    v_mov_b32 v44, 0
    v_mov_b32 v45, 0
    v_mov_b32 v46, 0
    v_mov_b32 v47, 0
    v_mov_b32 v48, 0
    v_mov_b32 v49, 0
    v_mov_b32 v50, 0
    v_mov_b32 v51, 0
    v_mov_b32 v52, 0
    v_mov_b32 v53, 0
    v_mov_b32 v54, 0
    v_mov_b32 v55, 0
    v_mov_b32 v56, 0
    v_mov_b32 v57, 0
    v_mov_b32 v58, 0
    v_mov_b32 v59, 0
    v_mov_b32 v60, 0
    v_mov_b32 v61, 0
    v_mov_b32 v62, 0
    v_mov_b32 v63, 0
    v_mov_b32 v226, 0
    v_mov_b32 v227, 0
    v_mov_b32 v228, 0
    v_mov_b32 v229, 0
    v_mov_b32 v252, 0
    v_mov_b32 v253, 0
    v_mov_b32 v254, 0
    v_mov_b32 v255, 0
    v_mov_b32 v112, 0xff800000
    v_mov_b32 v113, 0xff800000
    s_mov_b32 s34, 0
    s_waitcnt vmcnt(0) lgkmcnt(0)
    s_nop 7
    s_nop 7
L_sl0:
    s_add_u32 m0, s48, 0
    s_nop 0
    buffer_load_dwordx4 v96, s[16:19], s34 offen lds
    s_add_u32 m0, s48, 81920
    s_nop 0
    buffer_load_dwordx4 v104, s[20:23], s34 offen lds
    s_add_u32 m0, s48, 1024
    s_nop 0
    buffer_load_dwordx4 v97, s[16:19], s34 offen lds
    s_add_u32 m0, s48, 82944
    s_nop 0
    buffer_load_dwordx4 v105, s[20:23], s34 offen lds
    s_add_u32 m0, s48, 2048
    s_nop 0
    buffer_load_dwordx4 v98, s[16:19], s34 offen lds
    s_add_u32 m0, s48, 83968
    s_nop 0
    buffer_load_dwordx4 v106, s[20:23], s34 offen lds
    s_add_u32 m0, s48, 3072
    s_nop 0
    buffer_load_dwordx4 v99, s[16:19], s34 offen lds
    s_add_u32 m0, s48, 84992
    s_nop 0
    buffer_load_dwordx4 v107, s[20:23], s34 offen lds
    s_add_u32 m0, s48, 4096
    s_nop 0
    buffer_load_dwordx4 v100, s[16:19], s34 offen lds
    s_add_u32 m0, s48, 86016
    s_nop 0
    buffer_load_dwordx4 v108, s[20:23], s34 offen lds
    s_add_u32 m0, s48, 5120
    s_nop 0
    buffer_load_dwordx4 v101, s[16:19], s34 offen lds
    s_add_u32 m0, s48, 87040
    s_nop 0
    buffer_load_dwordx4 v109, s[20:23], s34 offen lds
    s_add_u32 m0, s48, 6144
    s_nop 0
    buffer_load_dwordx4 v102, s[16:19], s34 offen lds
    s_add_u32 m0, s48, 88064
    s_nop 0
    buffer_load_dwordx4 v110, s[20:23], s34 offen lds
    s_add_u32 m0, s48, 7168
    s_nop 0
    buffer_load_dwordx4 v103, s[16:19], s34 offen lds
    s_add_u32 m0, s48, 89088
    s_nop 0
    buffer_load_dwordx4 v111, s[20:23], s34 offen lds
    s_waitcnt vmcnt(0) lgkmcnt(0)
    s_nop 7
    s_nop 7
    ds_read_b128 v[176:179], v208 offset:0
    ds_read_b128 v[180:183], v209 offset:0
    ds_read_b128 v[184:187], v210 offset:0
    ds_read_b128 v[188:191], v211 offset:0
    ds_read_b128 v[192:195], v208 offset:4096
    ds_read_b128 v[196:199], v209 offset:4096
    ds_read_b128 v[200:203], v210 offset:4096
    ds_read_b128 v[204:207], v211 offset:4096
    s_waitcnt lgkmcnt(7)
    v_mfma_f32_16x16x32_bf16 v[128:131], v[176:179], v[64:67], 0
    v_mfma_f32_16x16x32_bf16 v[136:139], v[176:179], v[68:71], 0
    s_waitcnt lgkmcnt(6)
    v_mfma_f32_16x16x32_bf16 v[128:131], v[180:183], v[72:75], v[128:131]
    v_mfma_f32_16x16x32_bf16 v[136:139], v[180:183], v[76:79], v[136:139]
    s_waitcnt lgkmcnt(5)
    v_mfma_f32_16x16x32_bf16 v[128:131], v[184:187], v[80:83], v[128:131]
    v_mfma_f32_16x16x32_bf16 v[136:139], v[184:187], v[84:87], v[136:139]
    s_waitcnt lgkmcnt(4)
    v_mfma_f32_16x16x32_bf16 v[128:131], v[188:191], v[88:91], v[128:131]
    v_mfma_f32_16x16x32_bf16 v[136:139], v[188:191], v[92:95], v[136:139]
    s_waitcnt lgkmcnt(3)
    v_mfma_f32_16x16x32_bf16 v[132:135], v[192:195], v[64:67], 0
    v_mfma_f32_16x16x32_bf16 v[140:143], v[192:195], v[68:71], 0
    s_waitcnt lgkmcnt(2)
    v_mfma_f32_16x16x32_bf16 v[132:135], v[196:199], v[72:75], v[132:135]
    v_mfma_f32_16x16x32_bf16 v[140:143], v[196:199], v[76:79], v[140:143]
    s_waitcnt lgkmcnt(1)
    v_mfma_f32_16x16x32_bf16 v[132:135], v[200:203], v[80:83], v[132:135]
    v_mfma_f32_16x16x32_bf16 v[140:143], v[200:203], v[84:87], v[140:143]
    s_waitcnt lgkmcnt(0)
    v_mfma_f32_16x16x32_bf16 v[132:135], v[204:207], v[88:91], v[132:135]
    v_mfma_f32_16x16x32_bf16 v[140:143], v[204:207], v[92:95], v[140:143]
    ds_read_b64_tr_b16 v[144:145], v212 offset:0
    ds_read_b64_tr_b16 v[146:147], v212 offset:4096
    ds_read_b64_tr_b16 v[148:149], v213 offset:0
    ds_read_b64_tr_b16 v[150:151], v213 offset:4096
    ds_read_b64_tr_b16 v[152:153], v214 offset:0
    ds_read_b64_tr_b16 v[154:155], v214 offset:4096
    ds_read_b64_tr_b16 v[156:157], v215 offset:0
    ds_read_b64_tr_b16 v[158:159], v215 offset:4096
    ds_read_b64_tr_b16 v[168:169], v216 offset:0
    ds_read_b64_tr_b16 v[170:171], v216 offset:4096
    ds_read_b64_tr_b16 v[172:173], v217 offset:0
    ds_read_b64_tr_b16 v[174:175], v217 offset:4096
    ds_read_b64_tr_b16 v[176:177], v218 offset:0
    ds_read_b64_tr_b16 v[178:179], v218 offset:4096
    ds_read_b64_tr_b16 v[180:181], v219 offset:0
    ds_read_b64_tr_b16 v[182:183], v219 offset:4096
    v_max3_f32 v120, v112, v128, v129
    v_max3_f32 v121, v113, v136, v137
    v_max3_f32 v120, v120, v130, v131
    v_max3_f32 v121, v121, v138, v139
    v_max3_f32 v120, v120, v132, v133
    v_max3_f32 v121, v121, v140, v141
    v_max3_f32 v120, v120, v134, v135
    v_max3_f32 v121, v121, v142, v143
    v_mov_b32 v122, v120
    v_mov_b32 v123, v121
    s_nop 0
    v_permlane16_swap_b32 v120, v122
    v_permlane16_swap_b32 v121, v123
    v_max_f32 v120, v120, v122
    v_max_f32 v121, v121, v123
    v_mov_b32 v122, v120
    v_mov_b32 v123, v121
    s_nop 0
    v_permlane32_swap_b32 v120, v122
    v_permlane32_swap_b32 v121, v123
    v_max_f32 v120, v120, v122
    v_max_f32 v121, v121, v123
    v_sub_f32 v114, v112, v120
    v_mul_f32 v114, s32, v114
    v_exp_f32 v114, v114
    v_mov_b32 v112, v120
    v_sub_f32 v115, v113, v121
    v_mul_f32 v115, s32, v115
    v_exp_f32 v115, v115
    v_mov_b32 v113, v121
    v_mul_f32 v0, v0, v114
    v_mul_f32 v1, v1, v114
    v_mul_f32 v2, v2, v114
    v_mul_f32 v3, v3, v114
    v_mul_f32 v4, v4, v115
    v_mul_f32 v5, v5, v115
    v_mul_f32 v6, v6, v115
    v_mul_f32 v7, v7, v115
    v_mul_f32 v8, v8, v114
    v_mul_f32 v9, v9, v114
    v_mul_f32 v10, v10, v114
    v_mul_f32 v11, v11, v114
    v_mul_f32 v12, v12, v115
    v_mul_f32 v13, v13, v115
    v_mul_f32 v14, v14, v115
    v_mul_f32 v15, v15, v115
    v_mul_f32 v16, v16, v114
    v_mul_f32 v17, v17, v114
    v_mul_f32 v18, v18, v114
    v_mul_f32 v19, v19, v114
    v_mul_f32 v20, v20, v115
    v_mul_f32 v21, v21, v115
    v_mul_f32 v22, v22, v115
    v_mul_f32 v23, v23, v115
    v_mul_f32 v24, v24, v114
    v_mul_f32 v25, v25, v114
    v_mul_f32 v26, v26, v114
    v_mul_f32 v27, v27, v114
    v_mul_f32 v28, v28, v115
    v_mul_f32 v29, v29, v115
    v_mul_f32 v30, v30, v115
    v_mul_f32 v31, v31, v115
    v_mul_f32 v32, v32, v114
    v_mul_f32 v33, v33, v114
    v_mul_f32 v34, v34, v114
    v_mul_f32 v35, v35, v114
    v_mul_f32 v36, v36, v115
    v_mul_f32 v37, v37, v115
    v_mul_f32 v38, v38, v115
    v_mul_f32 v39, v39, v115
    v_mul_f32 v40, v40, v114
    v_mul_f32 v41, v41, v114
    v_mul_f32 v42, v42, v114
    v_mul_f32 v43, v43, v114
    v_mul_f32 v44, v44, v115
    v_mul_f32 v45, v45, v115
    v_mul_f32 v46, v46, v115
    v_mul_f32 v47, v47, v115
    v_mul_f32 v48, v48, v114
    v_mul_f32 v49, v49, v114
    v_mul_f32 v50, v50, v114
    v_mul_f32 v51, v51, v114
    v_mul_f32 v52, v52, v115
    v_mul_f32 v53, v53, v115
    v_mul_f32 v54, v54, v115
    v_mul_f32 v55, v55, v115
    v_mul_f32 v56, v56, v114
    v_mul_f32 v57, v57, v114
    v_mul_f32 v58, v58, v114
    v_mul_f32 v59, v59, v114
    v_mul_f32 v60, v60, v115
    v_mul_f32 v61, v61, v115
    v_mul_f32 v62, v62, v115
    v_mul_f32 v63, v63, v115
    v_mul_f32 v226, v226, v114
    v_mul_f32 v227, v227, v114
    v_mul_f32 v228, v228, v114
    v_mul_f32 v229, v229, v114
    v_mul_f32 v252, v252, v115
    v_mul_f32 v253, v253, v115
    v_mul_f32 v254, v254, v115
    v_mul_f32 v255, v255, v115
    v_sub_f32 v128, v128, v112
    v_sub_f32 v129, v129, v112
    v_sub_f32 v130, v130, v112
    v_sub_f32 v131, v131, v112
    v_sub_f32 v132, v132, v112
    v_sub_f32 v133, v133, v112
    v_sub_f32 v134, v134, v112
    v_sub_f32 v135, v135, v112
    v_sub_f32 v136, v136, v113
    v_sub_f32 v137, v137, v113
    v_sub_f32 v138, v138, v113
    v_sub_f32 v139, v139, v113
    v_sub_f32 v140, v140, v113
    v_sub_f32 v141, v141, v113
    v_sub_f32 v142, v142, v113
    v_sub_f32 v143, v143, v113
    v_mul_f32 v128, s32, v128
    v_mul_f32 v129, s32, v129
    v_mul_f32 v130, s32, v130
    v_mul_f32 v131, s32, v131
    v_mul_f32 v132, s32, v132
    v_mul_f32 v133, s32, v133
    v_mul_f32 v134, s32, v134
    v_mul_f32 v135, s32, v135
    v_mul_f32 v136, s32, v136
    v_mul_f32 v137, s32, v137
    v_mul_f32 v138, s32, v138
    v_mul_f32 v139, s32, v139
    v_mul_f32 v140, s32, v140
    v_mul_f32 v141, s32, v141
    v_mul_f32 v142, s32, v142
    v_mul_f32 v143, s32, v143
    v_exp_f32 v128, v128
    v_exp_f32 v129, v129
    v_exp_f32 v130, v130
    v_exp_f32 v131, v131
    v_exp_f32 v132, v132
    v_exp_f32 v133, v133
    v_exp_f32 v134, v134
    v_exp_f32 v135, v135
    v_exp_f32 v136, v136
    v_exp_f32 v137, v137
    v_exp_f32 v138, v138
    v_exp_f32 v139, v139
    v_exp_f32 v140, v140
    v_exp_f32 v141, v141
    v_exp_f32 v142, v142
    v_exp_f32 v143, v143
    v_cvt_pk_bf16_f32 v160, v128, v129
    v_cvt_pk_bf16_f32 v161, v130, v131
    v_cvt_pk_bf16_f32 v162, v132, v133
    v_cvt_pk_bf16_f32 v163, v134, v135
    v_cvt_pk_bf16_f32 v164, v136, v137
    v_cvt_pk_bf16_f32 v165, v138, v139
    v_cvt_pk_bf16_f32 v166, v140, v141
    v_cvt_pk_bf16_f32 v167, v142, v143
    v_mfma_f32_16x16x32_bf16 v[226:229], v[248:251], v[160:163], v[226:229]
    s_nop 0
    v_mfma_f32_16x16x32_bf16 v[252:255], v[248:251], v[164:167], v[252:255]
    s_waitcnt lgkmcnt(14)
    v_mfma_f32_16x16x32_bf16 v[0:3], v[144:147], v[160:163], v[0:3]
    v_mfma_f32_16x16x32_bf16 v[4:7], v[144:147], v[164:167], v[4:7]
    s_waitcnt lgkmcnt(12)
    v_mfma_f32_16x16x32_bf16 v[8:11], v[148:151], v[160:163], v[8:11]
    v_mfma_f32_16x16x32_bf16 v[12:15], v[148:151], v[164:167], v[12:15]
    s_waitcnt lgkmcnt(10)
    v_mfma_f32_16x16x32_bf16 v[16:19], v[152:155], v[160:163], v[16:19]
    v_mfma_f32_16x16x32_bf16 v[20:23], v[152:155], v[164:167], v[20:23]
    s_waitcnt lgkmcnt(8)
    v_mfma_f32_16x16x32_bf16 v[24:27], v[156:159], v[160:163], v[24:27]
    v_mfma_f32_16x16x32_bf16 v[28:31], v[156:159], v[164:167], v[28:31]
    s_waitcnt lgkmcnt(6)
    v_mfma_f32_16x16x32_bf16 v[32:35], v[168:171], v[160:163], v[32:35]
    v_mfma_f32_16x16x32_bf16 v[36:39], v[168:171], v[164:167], v[36:39]
    s_waitcnt lgkmcnt(4)
    v_mfma_f32_16x16x32_bf16 v[40:43], v[172:175], v[160:163], v[40:43]
    v_mfma_f32_16x16x32_bf16 v[44:47], v[172:175], v[164:167], v[44:47]
    s_waitcnt lgkmcnt(2)
    v_mfma_f32_16x16x32_bf16 v[48:51], v[176:179], v[160:163], v[48:51]
    v_mfma_f32_16x16x32_bf16 v[52:55], v[176:179], v[164:167], v[52:55]
    s_waitcnt lgkmcnt(0)
    v_mfma_f32_16x16x32_bf16 v[56:59], v[180:183], v[160:163], v[56:59]
    v_mfma_f32_16x16x32_bf16 v[60:63], v[180:183], v[164:167], v[60:63]
    s_waitcnt vmcnt(0) lgkmcnt(0)
    s_nop 7
    s_nop 7
    s_add_u32 s34, s34, 8192
    s_cmp_lt_u32 s34, 131072
    s_cbranch_scc1 L_sl0
    v_rcp_f32 v230, v226
    v_rcp_f32 v232, v252
    v_mul_f32 v0, v0, v230
    v_mul_f32 v1, v1, v230
    v_mul_f32 v2, v2, v230
    v_mul_f32 v3, v3, v230
    v_cvt_pk_bf16_f32 v64, v0, v1
    v_mul_f32 v4, v4, v232
    v_mul_f32 v5, v5, v232
    v_cvt_pk_bf16_f32 v65, v2, v3
    v_mul_f32 v6, v6, v232
    v_mul_f32 v7, v7, v232
    v_cvt_pk_bf16_f32 v68, v4, v5
    v_mul_f32 v8, v8, v230
    v_mul_f32 v9, v9, v230
    v_cvt_pk_bf16_f32 v69, v6, v7
    v_mul_f32 v10, v10, v230
    v_mul_f32 v11, v11, v230
    v_cvt_pk_bf16_f32 v66, v8, v9
    v_mul_f32 v12, v12, v232
    v_mul_f32 v13, v13, v232
    v_cvt_pk_bf16_f32 v67, v10, v11
    v_mul_f32 v14, v14, v232
    v_mul_f32 v15, v15, v232
    v_cvt_pk_bf16_f32 v70, v12, v13
    v_cvt_pk_bf16_f32 v71, v14, v15
    v_permlane16_swap_b32 v64, v66
    v_permlane16_swap_b32 v65, v67
    ds_bpermute_b32 v64, v225, v64
    ds_bpermute_b32 v65, v225, v65
    ds_bpermute_b32 v66, v225, v66
    ds_bpermute_b32 v67, v225, v67
    s_waitcnt lgkmcnt(0)
    buffer_store_dwordx4 v[64:67], v222, s[24:27], 0 offen offset:0
    v_permlane16_swap_b32 v68, v70
    v_permlane16_swap_b32 v69, v71
    ds_bpermute_b32 v68, v225, v68
    ds_bpermute_b32 v69, v225, v69
    ds_bpermute_b32 v70, v225, v70
    ds_bpermute_b32 v71, v225, v71
    s_waitcnt lgkmcnt(0)
    buffer_store_dwordx4 v[68:71], v222, s[24:27], 0 offen offset:256
    v_mul_f32 v16, v16, v230
    v_mul_f32 v17, v17, v230
    v_mul_f32 v18, v18, v230
    v_mul_f32 v19, v19, v230
    v_cvt_pk_bf16_f32 v72, v16, v17
    v_mul_f32 v20, v20, v232
    v_mul_f32 v21, v21, v232
    v_cvt_pk_bf16_f32 v73, v18, v19
    v_mul_f32 v22, v22, v232
    v_mul_f32 v23, v23, v232
    v_cvt_pk_bf16_f32 v76, v20, v21
    v_mul_f32 v24, v24, v230
    v_mul_f32 v25, v25, v230
    v_cvt_pk_bf16_f32 v77, v22, v23
    v_mul_f32 v26, v26, v230
    v_mul_f32 v27, v27, v230
    v_cvt_pk_bf16_f32 v74, v24, v25
    v_mul_f32 v28, v28, v232
    v_mul_f32 v29, v29, v232
    v_cvt_pk_bf16_f32 v75, v26, v27
    v_mul_f32 v30, v30, v232
    v_mul_f32 v31, v31, v232
    v_cvt_pk_bf16_f32 v78, v28, v29
    v_cvt_pk_bf16_f32 v79, v30, v31
    v_permlane16_swap_b32 v72, v74
    v_permlane16_swap_b32 v73, v75
    ds_bpermute_b32 v72, v225, v72
    ds_bpermute_b32 v73, v225, v73
    ds_bpermute_b32 v74, v225, v74
    ds_bpermute_b32 v75, v225, v75
    s_waitcnt lgkmcnt(0)
    buffer_store_dwordx4 v[72:75], v222, s[24:27], 0 offen offset:64
    v_permlane16_swap_b32 v76, v78
    v_permlane16_swap_b32 v77, v79
    ds_bpermute_b32 v76, v225, v76
    ds_bpermute_b32 v77, v225, v77
    ds_bpermute_b32 v78, v225, v78
    ds_bpermute_b32 v79, v225, v79
    s_waitcnt lgkmcnt(0)
    buffer_store_dwordx4 v[76:79], v222, s[24:27], 0 offen offset:320
    v_mul_f32 v32, v32, v230
    v_mul_f32 v33, v33, v230
    v_mul_f32 v34, v34, v230
    v_mul_f32 v35, v35, v230
    v_cvt_pk_bf16_f32 v80, v32, v33
    v_mul_f32 v36, v36, v232
    v_mul_f32 v37, v37, v232
    v_cvt_pk_bf16_f32 v81, v34, v35
    v_mul_f32 v38, v38, v232
    v_mul_f32 v39, v39, v232
    v_cvt_pk_bf16_f32 v84, v36, v37
    v_mul_f32 v40, v40, v230
    v_mul_f32 v41, v41, v230
    v_cvt_pk_bf16_f32 v85, v38, v39
    v_mul_f32 v42, v42, v230
    v_mul_f32 v43, v43, v230
    v_cvt_pk_bf16_f32 v82, v40, v41
    v_mul_f32 v44, v44, v232
    v_mul_f32 v45, v45, v232
    v_cvt_pk_bf16_f32 v83, v42, v43
    v_mul_f32 v46, v46, v232
    v_mul_f32 v47, v47, v232
    v_cvt_pk_bf16_f32 v86, v44, v45
    v_cvt_pk_bf16_f32 v87, v46, v47
    v_permlane16_swap_b32 v80, v82
    v_permlane16_swap_b32 v81, v83
    ds_bpermute_b32 v80, v225, v80
    ds_bpermute_b32 v81, v225, v81
    ds_bpermute_b32 v82, v225, v82
    ds_bpermute_b32 v83, v225, v83
    s_waitcnt lgkmcnt(0)
    buffer_store_dwordx4 v[80:83], v222, s[24:27], 0 offen offset:128
    v_permlane16_swap_b32 v84, v86
    v_permlane16_swap_b32 v85, v87
    ds_bpermute_b32 v84, v225, v84
    ds_bpermute_b32 v85, v225, v85
    ds_bpermute_b32 v86, v225, v86
    ds_bpermute_b32 v87, v225, v87
    s_waitcnt lgkmcnt(0)
    buffer_store_dwordx4 v[84:87], v222, s[24:27], 0 offen offset:384
    v_mul_f32 v48, v48, v230
    v_mul_f32 v49, v49, v230
    v_mul_f32 v50, v50, v230
    v_mul_f32 v51, v51, v230
    v_cvt_pk_bf16_f32 v88, v48, v49
    v_mul_f32 v52, v52, v232
    v_mul_f32 v53, v53, v232
    v_cvt_pk_bf16_f32 v89, v50, v51
    v_mul_f32 v54, v54, v232
    v_mul_f32 v55, v55, v232
    v_cvt_pk_bf16_f32 v92, v52, v53
    v_mul_f32 v56, v56, v230
    v_mul_f32 v57, v57, v230
    v_cvt_pk_bf16_f32 v93, v54, v55
    v_mul_f32 v58, v58, v230
    v_mul_f32 v59, v59, v230
    v_cvt_pk_bf16_f32 v90, v56, v57
    v_mul_f32 v60, v60, v232
    v_mul_f32 v61, v61, v232
    v_cvt_pk_bf16_f32 v91, v58, v59
    v_mul_f32 v62, v62, v232
    v_mul_f32 v63, v63, v232
    v_cvt_pk_bf16_f32 v94, v60, v61
    v_cvt_pk_bf16_f32 v95, v62, v63
    v_permlane16_swap_b32 v88, v90
    v_permlane16_swap_b32 v89, v91
    ds_bpermute_b32 v88, v225, v88
    ds_bpermute_b32 v89, v225, v89
    ds_bpermute_b32 v90, v225, v90
    ds_bpermute_b32 v91, v225, v91
    s_waitcnt lgkmcnt(0)
    buffer_store_dwordx4 v[88:91], v222, s[24:27], 0 offen offset:192
    v_permlane16_swap_b32 v92, v94
    v_permlane16_swap_b32 v93, v95
    ds_bpermute_b32 v92, v225, v92
    ds_bpermute_b32 v93, v225, v93
    ds_bpermute_b32 v94, v225, v94
    ds_bpermute_b32 v95, v225, v95
    s_waitcnt lgkmcnt(0)
    buffer_store_dwordx4 v[92:95], v222, s[24:27], 0 offen offset:448
    s_waitcnt vmcnt(0) lgkmcnt(0)
    s_nop 7
    s_nop 7
L_sk0:
    s_cmp_eq_u64 s[38:39], 0
    s_cbranch_scc1 L_sk1
    v_mbcnt_lo_u32_b32 v116, -1, 0
    v_mbcnt_hi_u32_b32 v116, -1, v116
    v_and_b32 v117, 15, v116
    v_lshrrev_b32 v116, 4, v116
    v_add_u32 v118, 0, v116
    v_and_b32 v119, 15, v118
    v_xor_b32 v119, v119, v117
    v_lshlrev_b32 v119, 4, v119
    v_lshl_add_u32 v96, v118, 8, v119
    v_and_b32 v119, 7, v118
    v_lshlrev_b32 v119, 1, v119
    v_xor_b32 v119, v119, v117
    v_lshlrev_b32 v119, 4, v119
    v_lshl_add_u32 v104, v118, 8, v119
    v_add_u32 v118, 4, v116
    v_and_b32 v119, 15, v118
    v_xor_b32 v119, v119, v117
    v_lshlrev_b32 v119, 4, v119
    v_lshl_add_u32 v97, v118, 8, v119
    v_and_b32 v119, 7, v118
    v_lshlrev_b32 v119, 1, v119
    v_xor_b32 v119, v119, v117
    v_lshlrev_b32 v119, 4, v119
    v_lshl_add_u32 v105, v118, 8, v119
    v_add_u32 v118, 8, v116
    v_and_b32 v119, 15, v118
    v_xor_b32 v119, v119, v117
    v_lshlrev_b32 v119, 4, v119
    v_lshl_add_u32 v98, v118, 8, v119
    v_and_b32 v119, 7, v118
    v_lshlrev_b32 v119, 1, v119
    v_xor_b32 v119, v119, v117
    v_lshlrev_b32 v119, 4, v119
    v_lshl_add_u32 v106, v118, 8, v119
    v_add_u32 v118, 12, v116
    v_and_b32 v119, 15, v118
    v_xor_b32 v119, v119, v117
    v_lshlrev_b32 v119, 4, v119
    v_lshl_add_u32 v99, v118, 8, v119
    v_and_b32 v119, 7, v118
    v_lshlrev_b32 v119, 1, v119
    v_xor_b32 v119, v119, v117
    v_lshlrev_b32 v119, 4, v119
    v_lshl_add_u32 v107, v118, 8, v119
    v_add_u32 v118, 16, v116
    v_and_b32 v119, 15, v118
    v_xor_b32 v119, v119, v117
    v_lshlrev_b32 v119, 4, v119
    v_lshl_add_u32 v100, v118, 8, v119
    v_and_b32 v119, 7, v118
    v_lshlrev_b32 v119, 1, v119
    v_xor_b32 v119, v119, v117
    v_lshlrev_b32 v119, 4, v119
    v_lshl_add_u32 v108, v118, 8, v119
    v_add_u32 v118, 20, v116
    v_and_b32 v119, 15, v118
    v_xor_b32 v119, v119, v117
    v_lshlrev_b32 v119, 4, v119
    v_lshl_add_u32 v101, v118, 8, v119
    v_and_b32 v119, 7, v118
    v_lshlrev_b32 v119, 1, v119
    v_xor_b32 v119, v119, v117
    v_lshlrev_b32 v119, 4, v119
    v_lshl_add_u32 v109, v118, 8, v119
    v_add_u32 v118, 24, v116
    v_and_b32 v119, 15, v118
    v_xor_b32 v119, v119, v117
    v_lshlrev_b32 v119, 4, v119
    v_lshl_add_u32 v102, v118, 8, v119
    v_and_b32 v119, 7, v118
    v_lshlrev_b32 v119, 1, v119
    v_xor_b32 v119, v119, v117
    v_lshlrev_b32 v119, 4, v119
    v_lshl_add_u32 v110, v118, 8, v119
    v_add_u32 v118, 28, v116
    v_and_b32 v119, 15, v118
    v_xor_b32 v119, v119, v117
    v_lshlrev_b32 v119, 4, v119
    v_lshl_add_u32 v103, v118, 8, v119
    v_and_b32 v119, 7, v118
    v_lshlrev_b32 v119, 1, v119
    v_xor_b32 v119, v119, v117
    v_lshlrev_b32 v119, 4, v119
    v_lshl_add_u32 v111, v118, 8, v119
    buffer_load_dwordx4 v[64:67], v223, s[12:15], 0 offen offset:0
    buffer_load_dwordx4 v[68:71], v223, s[12:15], 0 offen offset:256
    buffer_load_dwordx4 v[72:75], v223, s[12:15], 0 offen offset:64
    buffer_load_dwordx4 v[76:79], v223, s[12:15], 0 offen offset:320
    buffer_load_dwordx4 v[80:83], v223, s[12:15], 0 offen offset:128
    buffer_load_dwordx4 v[84:87], v223, s[12:15], 0 offen offset:384
    buffer_load_dwordx4 v[88:91], v223, s[12:15], 0 offen offset:192
    buffer_load_dwordx4 v[92:95], v223, s[12:15], 0 offen offset:448
    s_waitcnt vmcnt(7)
    ds_bpermute_b32 v64, v224, v64
    ds_bpermute_b32 v65, v224, v65
    ds_bpermute_b32 v66, v224, v66
    ds_bpermute_b32 v67, v224, v67
    s_waitcnt vmcnt(6)
    ds_bpermute_b32 v68, v224, v68
    ds_bpermute_b32 v69, v224, v69
    ds_bpermute_b32 v70, v224, v70
    ds_bpermute_b32 v71, v224, v71
    s_waitcnt vmcnt(5)
    ds_bpermute_b32 v72, v224, v72
    ds_bpermute_b32 v73, v224, v73
    ds_bpermute_b32 v74, v224, v74
    ds_bpermute_b32 v75, v224, v75
    s_waitcnt vmcnt(4)
    ds_bpermute_b32 v76, v224, v76
    ds_bpermute_b32 v77, v224, v77
    ds_bpermute_b32 v78, v224, v78
    ds_bpermute_b32 v79, v224, v79
    s_waitcnt vmcnt(3)
    ds_bpermute_b32 v80, v224, v80
    ds_bpermute_b32 v81, v224, v81
    ds_bpermute_b32 v82, v224, v82
    ds_bpermute_b32 v83, v224, v83
    s_waitcnt vmcnt(2)
    ds_bpermute_b32 v84, v224, v84
    ds_bpermute_b32 v85, v224, v85
    ds_bpermute_b32 v86, v224, v86
    ds_bpermute_b32 v87, v224, v87
    s_waitcnt vmcnt(1)
    ds_bpermute_b32 v88, v224, v88
    ds_bpermute_b32 v89, v224, v89
    ds_bpermute_b32 v90, v224, v90
    ds_bpermute_b32 v91, v224, v91
    s_waitcnt vmcnt(0)
    ds_bpermute_b32 v92, v224, v92
    ds_bpermute_b32 v93, v224, v93
    ds_bpermute_b32 v94, v224, v94
    ds_bpermute_b32 v95, v224, v95
    v_mov_b32 v0, 0
    v_mov_b32 v1, 0
    v_mov_b32 v2, 0
    v_mov_b32 v3, 0
    v_mov_b32 v4, 0
    v_mov_b32 v5, 0
    v_mov_b32 v6, 0
    v_mov_b32 v7, 0
    v_mov_b32 v8, 0
    v_mov_b32 v9, 0
    v_mov_b32 v10, 0
    v_mov_b32 v11, 0
    v_mov_b32 v12, 0
    v_mov_b32 v13, 0
    v_mov_b32 v14, 0
    v_mov_b32 v15, 0
    v_mov_b32 v16, 0
    v_mov_b32 v17, 0
    v_mov_b32 v18, 0
    v_mov_b32 v19, 0
    v_mov_b32 v20, 0
    v_mov_b32 v21, 0
    v_mov_b32 v22, 0
    v_mov_b32 v23, 0
    v_mov_b32 v24, 0
    v_mov_b32 v25, 0
    v_mov_b32 v26, 0
    v_mov_b32 v27, 0
    v_mov_b32 v28, 0
    v_mov_b32 v29, 0
    v_mov_b32 v30, 0
    v_mov_b32 v31, 0
    v_mov_b32 v32, 0
    v_mov_b32 v33, 0
    v_mov_b32 v34, 0
    v_mov_b32 v35, 0
    v_mov_b32 v36, 0
    v_mov_b32 v37, 0
    v_mov_b32 v38, 0
    v_mov_b32 v39, 0
    v_mov_b32 v40, 0
    v_mov_b32 v41, 0
    v_mov_b32 v42, 0
    v_mov_b32 v43, 0
    v_mov_b32 v44, 0
    v_mov_b32 v45, 0
    v_mov_b32 v46, 0
    v_mov_b32 v47, 0
    v_mov_b32 v48, 0
    v_mov_b32 v49, 0
    v_mov_b32 v50, 0
    v_mov_b32 v51, 0
    v_mov_b32 v52, 0
    v_mov_b32 v53, 0
    v_mov_b32 v54, 0
    v_mov_b32 v55, 0
    v_mov_b32 v56, 0
    v_mov_b32 v57, 0
    v_mov_b32 v58, 0
    v_mov_b32 v59, 0
    v_mov_b32 v60, 0
    v_mov_b32 v61, 0
    v_mov_b32 v62, 0
    v_mov_b32 v63, 0
    v_mov_b32 v226, 0
    v_mov_b32 v227, 0
    v_mov_b32 v228, 0
    v_mov_b32 v229, 0
    v_mov_b32 v252, 0
    v_mov_b32 v253, 0
    v_mov_b32 v254, 0
    v_mov_b32 v255, 0
    v_mov_b32 v112, 0xff800000
    v_mov_b32 v113, 0xff800000
    s_mov_b32 s34, 131072
    s_waitcnt vmcnt(0) lgkmcnt(0)
    s_nop 7
    s_nop 7
L_sl1:
    s_add_u32 m0, s48, 0
    s_nop 0
    buffer_load_dwordx4 v96, s[16:19], s34 offen lds
    s_add_u32 m0, s48, 81920
    s_nop 0
    buffer_load_dwordx4 v104, s[20:23], s34 offen lds
    s_add_u32 m0, s48, 1024
    s_nop 0
    buffer_load_dwordx4 v97, s[16:19], s34 offen lds
    s_add_u32 m0, s48, 82944
    s_nop 0
    buffer_load_dwordx4 v105, s[20:23], s34 offen lds
    s_add_u32 m0, s48, 2048
    s_nop 0
    buffer_load_dwordx4 v98, s[16:19], s34 offen lds
    s_add_u32 m0, s48, 83968
    s_nop 0
    buffer_load_dwordx4 v106, s[20:23], s34 offen lds
    s_add_u32 m0, s48, 3072
    s_nop 0
    buffer_load_dwordx4 v99, s[16:19], s34 offen lds
    s_add_u32 m0, s48, 84992
    s_nop 0
    buffer_load_dwordx4 v107, s[20:23], s34 offen lds
    s_add_u32 m0, s48, 4096
    s_nop 0
    buffer_load_dwordx4 v100, s[16:19], s34 offen lds
    s_add_u32 m0, s48, 86016
    s_nop 0
    buffer_load_dwordx4 v108, s[20:23], s34 offen lds
    s_add_u32 m0, s48, 5120
    s_nop 0
    buffer_load_dwordx4 v101, s[16:19], s34 offen lds
    s_add_u32 m0, s48, 87040
    s_nop 0
    buffer_load_dwordx4 v109, s[20:23], s34 offen lds
    s_add_u32 m0, s48, 6144
    s_nop 0
    buffer_load_dwordx4 v102, s[16:19], s34 offen lds
    s_add_u32 m0, s48, 88064
    s_nop 0
    buffer_load_dwordx4 v110, s[20:23], s34 offen lds
    s_add_u32 m0, s48, 7168
    s_nop 0
    buffer_load_dwordx4 v103, s[16:19], s34 offen lds
    s_add_u32 m0, s48, 89088
    s_nop 0
    buffer_load_dwordx4 v111, s[20:23], s34 offen lds
    s_waitcnt vmcnt(0) lgkmcnt(0)
    s_nop 7
    s_nop 7
    ds_read_b128 v[176:179], v208 offset:0
    ds_read_b128 v[180:183], v209 offset:0
    ds_read_b128 v[184:187], v210 offset:0
    ds_read_b128 v[188:191], v211 offset:0
    ds_read_b128 v[192:195], v208 offset:4096
    ds_read_b128 v[196:199], v209 offset:4096
    ds_read_b128 v[200:203], v210 offset:4096
    ds_read_b128 v[204:207], v211 offset:4096
    s_waitcnt lgkmcnt(7)
    v_mfma_f32_16x16x32_bf16 v[128:131], v[176:179], v[64:67], 0
    v_mfma_f32_16x16x32_bf16 v[136:139], v[176:179], v[68:71], 0
    s_waitcnt lgkmcnt(6)
    v_mfma_f32_16x16x32_bf16 v[128:131], v[180:183], v[72:75], v[128:131]
    v_mfma_f32_16x16x32_bf16 v[136:139], v[180:183], v[76:79], v[136:139]
    s_waitcnt lgkmcnt(5)
    v_mfma_f32_16x16x32_bf16 v[128:131], v[184:187], v[80:83], v[128:131]
    v_mfma_f32_16x16x32_bf16 v[136:139], v[184:187], v[84:87], v[136:139]
    s_waitcnt lgkmcnt(4)
    v_mfma_f32_16x16x32_bf16 v[128:131], v[188:191], v[88:91], v[128:131]
    v_mfma_f32_16x16x32_bf16 v[136:139], v[188:191], v[92:95], v[136:139]
    s_waitcnt lgkmcnt(3)
    v_mfma_f32_16x16x32_bf16 v[132:135], v[192:195], v[64:67], 0
    v_mfma_f32_16x16x32_bf16 v[140:143], v[192:195], v[68:71], 0
    s_waitcnt lgkmcnt(2)
    v_mfma_f32_16x16x32_bf16 v[132:135], v[196:199], v[72:75], v[132:135]
    v_mfma_f32_16x16x32_bf16 v[140:143], v[196:199], v[76:79], v[140:143]
    s_waitcnt lgkmcnt(1)
    v_mfma_f32_16x16x32_bf16 v[132:135], v[200:203], v[80:83], v[132:135]
    v_mfma_f32_16x16x32_bf16 v[140:143], v[200:203], v[84:87], v[140:143]
    s_waitcnt lgkmcnt(0)
    v_mfma_f32_16x16x32_bf16 v[132:135], v[204:207], v[88:91], v[132:135]
    v_mfma_f32_16x16x32_bf16 v[140:143], v[204:207], v[92:95], v[140:143]
    ds_read_b64_tr_b16 v[144:145], v212 offset:0
    ds_read_b64_tr_b16 v[146:147], v212 offset:4096
    ds_read_b64_tr_b16 v[148:149], v213 offset:0
    ds_read_b64_tr_b16 v[150:151], v213 offset:4096
    ds_read_b64_tr_b16 v[152:153], v214 offset:0
    ds_read_b64_tr_b16 v[154:155], v214 offset:4096
    ds_read_b64_tr_b16 v[156:157], v215 offset:0
    ds_read_b64_tr_b16 v[158:159], v215 offset:4096
    ds_read_b64_tr_b16 v[168:169], v216 offset:0
    ds_read_b64_tr_b16 v[170:171], v216 offset:4096
    ds_read_b64_tr_b16 v[172:173], v217 offset:0
    ds_read_b64_tr_b16 v[174:175], v217 offset:4096
    ds_read_b64_tr_b16 v[176:177], v218 offset:0
    ds_read_b64_tr_b16 v[178:179], v218 offset:4096
    ds_read_b64_tr_b16 v[180:181], v219 offset:0
    ds_read_b64_tr_b16 v[182:183], v219 offset:4096
    v_max3_f32 v120, v112, v128, v129
    v_max3_f32 v121, v113, v136, v137
    v_max3_f32 v120, v120, v130, v131
    v_max3_f32 v121, v121, v138, v139
    v_max3_f32 v120, v120, v132, v133
    v_max3_f32 v121, v121, v140, v141
    v_max3_f32 v120, v120, v134, v135
    v_max3_f32 v121, v121, v142, v143
    v_mov_b32 v122, v120
    v_mov_b32 v123, v121
    s_nop 0
    v_permlane16_swap_b32 v120, v122
    v_permlane16_swap_b32 v121, v123
    v_max_f32 v120, v120, v122
    v_max_f32 v121, v121, v123
    v_mov_b32 v122, v120
    v_mov_b32 v123, v121
    s_nop 0
    v_permlane32_swap_b32 v120, v122
    v_permlane32_swap_b32 v121, v123
    v_max_f32 v120, v120, v122
    v_max_f32 v121, v121, v123
    v_sub_f32 v114, v112, v120
    v_mul_f32 v114, s32, v114
    v_exp_f32 v114, v114
    v_mov_b32 v112, v120
    v_sub_f32 v115, v113, v121
    v_mul_f32 v115, s32, v115
    v_exp_f32 v115, v115
    v_mov_b32 v113, v121
    v_mul_f32 v0, v0, v114
    v_mul_f32 v1, v1, v114
    v_mul_f32 v2, v2, v114
    v_mul_f32 v3, v3, v114
    v_mul_f32 v4, v4, v115
    v_mul_f32 v5, v5, v115
    v_mul_f32 v6, v6, v115
    v_mul_f32 v7, v7, v115
    v_mul_f32 v8, v8, v114
    v_mul_f32 v9, v9, v114
    v_mul_f32 v10, v10, v114
    v_mul_f32 v11, v11, v114
    v_mul_f32 v12, v12, v115
    v_mul_f32 v13, v13, v115
    v_mul_f32 v14, v14, v115
    v_mul_f32 v15, v15, v115
    v_mul_f32 v16, v16, v114
    v_mul_f32 v17, v17, v114
    v_mul_f32 v18, v18, v114
    v_mul_f32 v19, v19, v114
    v_mul_f32 v20, v20, v115
    v_mul_f32 v21, v21, v115
    v_mul_f32 v22, v22, v115
    v_mul_f32 v23, v23, v115
    v_mul_f32 v24, v24, v114
    v_mul_f32 v25, v25, v114
    v_mul_f32 v26, v26, v114
    v_mul_f32 v27, v27, v114
    v_mul_f32 v28, v28, v115
    v_mul_f32 v29, v29, v115
    v_mul_f32 v30, v30, v115
    v_mul_f32 v31, v31, v115
    v_mul_f32 v32, v32, v114
    v_mul_f32 v33, v33, v114
    v_mul_f32 v34, v34, v114
    v_mul_f32 v35, v35, v114
    v_mul_f32 v36, v36, v115
    v_mul_f32 v37, v37, v115
    v_mul_f32 v38, v38, v115
    v_mul_f32 v39, v39, v115
    v_mul_f32 v40, v40, v114
    v_mul_f32 v41, v41, v114
    v_mul_f32 v42, v42, v114
    v_mul_f32 v43, v43, v114
    v_mul_f32 v44, v44, v115
    v_mul_f32 v45, v45, v115
    v_mul_f32 v46, v46, v115
    v_mul_f32 v47, v47, v115
    v_mul_f32 v48, v48, v114
    v_mul_f32 v49, v49, v114
    v_mul_f32 v50, v50, v114
    v_mul_f32 v51, v51, v114
    v_mul_f32 v52, v52, v115
    v_mul_f32 v53, v53, v115
    v_mul_f32 v54, v54, v115
    v_mul_f32 v55, v55, v115
    v_mul_f32 v56, v56, v114
    v_mul_f32 v57, v57, v114
    v_mul_f32 v58, v58, v114
    v_mul_f32 v59, v59, v114
    v_mul_f32 v60, v60, v115
    v_mul_f32 v61, v61, v115
    v_mul_f32 v62, v62, v115
    v_mul_f32 v63, v63, v115
    v_mul_f32 v226, v226, v114
    v_mul_f32 v227, v227, v114
    v_mul_f32 v228, v228, v114
    v_mul_f32 v229, v229, v114
    v_mul_f32 v252, v252, v115
    v_mul_f32 v253, v253, v115
    v_mul_f32 v254, v254, v115
    v_mul_f32 v255, v255, v115
    v_sub_f32 v128, v128, v112
    v_sub_f32 v129, v129, v112
    v_sub_f32 v130, v130, v112
    v_sub_f32 v131, v131, v112
    v_sub_f32 v132, v132, v112
    v_sub_f32 v133, v133, v112
    v_sub_f32 v134, v134, v112
    v_sub_f32 v135, v135, v112
    v_sub_f32 v136, v136, v113
    v_sub_f32 v137, v137, v113
    v_sub_f32 v138, v138, v113
    v_sub_f32 v139, v139, v113
    v_sub_f32 v140, v140, v113
    v_sub_f32 v141, v141, v113
    v_sub_f32 v142, v142, v113
    v_sub_f32 v143, v143, v113
    v_mul_f32 v128, s32, v128
    v_mul_f32 v129, s32, v129
    v_mul_f32 v130, s32, v130
    v_mul_f32 v131, s32, v131
    v_mul_f32 v132, s32, v132
    v_mul_f32 v133, s32, v133
    v_mul_f32 v134, s32, v134
    v_mul_f32 v135, s32, v135
    v_mul_f32 v136, s32, v136
    v_mul_f32 v137, s32, v137
    v_mul_f32 v138, s32, v138
    v_mul_f32 v139, s32, v139
    v_mul_f32 v140, s32, v140
    v_mul_f32 v141, s32, v141
    v_mul_f32 v142, s32, v142
    v_mul_f32 v143, s32, v143
    v_exp_f32 v128, v128
    v_exp_f32 v129, v129
    v_exp_f32 v130, v130
    v_exp_f32 v131, v131
    v_exp_f32 v132, v132
    v_exp_f32 v133, v133
    v_exp_f32 v134, v134
    v_exp_f32 v135, v135
    v_exp_f32 v136, v136
    v_exp_f32 v137, v137
    v_exp_f32 v138, v138
    v_exp_f32 v139, v139
    v_exp_f32 v140, v140
    v_exp_f32 v141, v141
    v_exp_f32 v142, v142
    v_exp_f32 v143, v143
    v_cvt_pk_bf16_f32 v160, v128, v129
    v_cvt_pk_bf16_f32 v161, v130, v131
    v_cvt_pk_bf16_f32 v162, v132, v133
    v_cvt_pk_bf16_f32 v163, v134, v135
    v_cvt_pk_bf16_f32 v164, v136, v137
    v_cvt_pk_bf16_f32 v165, v138, v139
    v_cvt_pk_bf16_f32 v166, v140, v141
    v_cvt_pk_bf16_f32 v167, v142, v143
    v_mfma_f32_16x16x32_bf16 v[226:229], v[248:251], v[160:163], v[226:229]
    s_nop 0
    v_mfma_f32_16x16x32_bf16 v[252:255], v[248:251], v[164:167], v[252:255]
    s_waitcnt lgkmcnt(14)
    v_mfma_f32_16x16x32_bf16 v[0:3], v[144:147], v[160:163], v[0:3]
    v_mfma_f32_16x16x32_bf16 v[4:7], v[144:147], v[164:167], v[4:7]
    s_waitcnt lgkmcnt(12)
    v_mfma_f32_16x16x32_bf16 v[8:11], v[148:151], v[160:163], v[8:11]
    v_mfma_f32_16x16x32_bf16 v[12:15], v[148:151], v[164:167], v[12:15]
    s_waitcnt lgkmcnt(10)
    v_mfma_f32_16x16x32_bf16 v[16:19], v[152:155], v[160:163], v[16:19]
    v_mfma_f32_16x16x32_bf16 v[20:23], v[152:155], v[164:167], v[20:23]
    s_waitcnt lgkmcnt(8)
    v_mfma_f32_16x16x32_bf16 v[24:27], v[156:159], v[160:163], v[24:27]
    v_mfma_f32_16x16x32_bf16 v[28:31], v[156:159], v[164:167], v[28:31]
    s_waitcnt lgkmcnt(6)
    v_mfma_f32_16x16x32_bf16 v[32:35], v[168:171], v[160:163], v[32:35]
    v_mfma_f32_16x16x32_bf16 v[36:39], v[168:171], v[164:167], v[36:39]
    s_waitcnt lgkmcnt(4)
    v_mfma_f32_16x16x32_bf16 v[40:43], v[172:175], v[160:163], v[40:43]
    v_mfma_f32_16x16x32_bf16 v[44:47], v[172:175], v[164:167], v[44:47]
    s_waitcnt lgkmcnt(2)
    v_mfma_f32_16x16x32_bf16 v[48:51], v[176:179], v[160:163], v[48:51]
    v_mfma_f32_16x16x32_bf16 v[52:55], v[176:179], v[164:167], v[52:55]
    s_waitcnt lgkmcnt(0)
    v_mfma_f32_16x16x32_bf16 v[56:59], v[180:183], v[160:163], v[56:59]
    v_mfma_f32_16x16x32_bf16 v[60:63], v[180:183], v[164:167], v[60:63]
    s_waitcnt vmcnt(0) lgkmcnt(0)
    s_nop 7
    s_nop 7
    s_add_u32 s34, s34, 8192
    s_cmp_lt_u32 s34, 262144
    s_cbranch_scc1 L_sl1
    v_rcp_f32 v230, v226
    v_rcp_f32 v232, v252
    v_mul_f32 v0, v0, v230
    v_mul_f32 v1, v1, v230
    v_mul_f32 v2, v2, v230
    v_mul_f32 v3, v3, v230
    v_cvt_pk_bf16_f32 v64, v0, v1
    v_mul_f32 v4, v4, v232
    v_mul_f32 v5, v5, v232
    v_cvt_pk_bf16_f32 v65, v2, v3
    v_mul_f32 v6, v6, v232
    v_mul_f32 v7, v7, v232
    v_cvt_pk_bf16_f32 v68, v4, v5
    v_mul_f32 v8, v8, v230
    v_mul_f32 v9, v9, v230
    v_cvt_pk_bf16_f32 v69, v6, v7
    v_mul_f32 v10, v10, v230
    v_mul_f32 v11, v11, v230
    v_cvt_pk_bf16_f32 v66, v8, v9
    v_mul_f32 v12, v12, v232
    v_mul_f32 v13, v13, v232
    v_cvt_pk_bf16_f32 v67, v10, v11
    v_mul_f32 v14, v14, v232
    v_mul_f32 v15, v15, v232
    v_cvt_pk_bf16_f32 v70, v12, v13
    v_cvt_pk_bf16_f32 v71, v14, v15
    v_permlane16_swap_b32 v64, v66
    v_permlane16_swap_b32 v65, v67
    ds_bpermute_b32 v64, v225, v64
    ds_bpermute_b32 v65, v225, v65
    ds_bpermute_b32 v66, v225, v66
    ds_bpermute_b32 v67, v225, v67
    s_waitcnt lgkmcnt(0)
    buffer_store_dwordx4 v[64:67], v223, s[28:31], 0 offen offset:0
    v_permlane16_swap_b32 v68, v70
    v_permlane16_swap_b32 v69, v71
    ds_bpermute_b32 v68, v225, v68
    ds_bpermute_b32 v69, v225, v69
    ds_bpermute_b32 v70, v225, v70
    ds_bpermute_b32 v71, v225, v71
    s_waitcnt lgkmcnt(0)
    buffer_store_dwordx4 v[68:71], v223, s[28:31], 0 offen offset:256
    v_mul_f32 v16, v16, v230
    v_mul_f32 v17, v17, v230
    v_mul_f32 v18, v18, v230
    v_mul_f32 v19, v19, v230
    v_cvt_pk_bf16_f32 v72, v16, v17
    v_mul_f32 v20, v20, v232
    v_mul_f32 v21, v21, v232
    v_cvt_pk_bf16_f32 v73, v18, v19
    v_mul_f32 v22, v22, v232
    v_mul_f32 v23, v23, v232
    v_cvt_pk_bf16_f32 v76, v20, v21
    v_mul_f32 v24, v24, v230
    v_mul_f32 v25, v25, v230
    v_cvt_pk_bf16_f32 v77, v22, v23
    v_mul_f32 v26, v26, v230
    v_mul_f32 v27, v27, v230
    v_cvt_pk_bf16_f32 v74, v24, v25
    v_mul_f32 v28, v28, v232
    v_mul_f32 v29, v29, v232
    v_cvt_pk_bf16_f32 v75, v26, v27
    v_mul_f32 v30, v30, v232
    v_mul_f32 v31, v31, v232
    v_cvt_pk_bf16_f32 v78, v28, v29
    v_cvt_pk_bf16_f32 v79, v30, v31
    v_permlane16_swap_b32 v72, v74
    v_permlane16_swap_b32 v73, v75
    ds_bpermute_b32 v72, v225, v72
    ds_bpermute_b32 v73, v225, v73
    ds_bpermute_b32 v74, v225, v74
    ds_bpermute_b32 v75, v225, v75
    s_waitcnt lgkmcnt(0)
    buffer_store_dwordx4 v[72:75], v223, s[28:31], 0 offen offset:64
    v_permlane16_swap_b32 v76, v78
    v_permlane16_swap_b32 v77, v79
    ds_bpermute_b32 v76, v225, v76
    ds_bpermute_b32 v77, v225, v77
    ds_bpermute_b32 v78, v225, v78
    ds_bpermute_b32 v79, v225, v79
    s_waitcnt lgkmcnt(0)
    buffer_store_dwordx4 v[76:79], v223, s[28:31], 0 offen offset:320
    v_mul_f32 v32, v32, v230
    v_mul_f32 v33, v33, v230
    v_mul_f32 v34, v34, v230
    v_mul_f32 v35, v35, v230
    v_cvt_pk_bf16_f32 v80, v32, v33
    v_mul_f32 v36, v36, v232
    v_mul_f32 v37, v37, v232
    v_cvt_pk_bf16_f32 v81, v34, v35
    v_mul_f32 v38, v38, v232
    v_mul_f32 v39, v39, v232
    v_cvt_pk_bf16_f32 v84, v36, v37
    v_mul_f32 v40, v40, v230
    v_mul_f32 v41, v41, v230
    v_cvt_pk_bf16_f32 v85, v38, v39
    v_mul_f32 v42, v42, v230
    v_mul_f32 v43, v43, v230
    v_cvt_pk_bf16_f32 v82, v40, v41
    v_mul_f32 v44, v44, v232
    v_mul_f32 v45, v45, v232
    v_cvt_pk_bf16_f32 v83, v42, v43
    v_mul_f32 v46, v46, v232
    v_mul_f32 v47, v47, v232
    v_cvt_pk_bf16_f32 v86, v44, v45
    v_cvt_pk_bf16_f32 v87, v46, v47
    v_permlane16_swap_b32 v80, v82
    v_permlane16_swap_b32 v81, v83
    ds_bpermute_b32 v80, v225, v80
    ds_bpermute_b32 v81, v225, v81
    ds_bpermute_b32 v82, v225, v82
    ds_bpermute_b32 v83, v225, v83
    s_waitcnt lgkmcnt(0)
    buffer_store_dwordx4 v[80:83], v223, s[28:31], 0 offen offset:128
    v_permlane16_swap_b32 v84, v86
    v_permlane16_swap_b32 v85, v87
    ds_bpermute_b32 v84, v225, v84
    ds_bpermute_b32 v85, v225, v85
    ds_bpermute_b32 v86, v225, v86
    ds_bpermute_b32 v87, v225, v87
    s_waitcnt lgkmcnt(0)
    buffer_store_dwordx4 v[84:87], v223, s[28:31], 0 offen offset:384
    v_mul_f32 v48, v48, v230
    v_mul_f32 v49, v49, v230
    v_mul_f32 v50, v50, v230
    v_mul_f32 v51, v51, v230
    v_cvt_pk_bf16_f32 v88, v48, v49
    v_mul_f32 v52, v52, v232
    v_mul_f32 v53, v53, v232
    v_cvt_pk_bf16_f32 v89, v50, v51
    v_mul_f32 v54, v54, v232
    v_mul_f32 v55, v55, v232
    v_cvt_pk_bf16_f32 v92, v52, v53
    v_mul_f32 v56, v56, v230
    v_mul_f32 v57, v57, v230
    v_cvt_pk_bf16_f32 v93, v54, v55
    v_mul_f32 v58, v58, v230
    v_mul_f32 v59, v59, v230
    v_cvt_pk_bf16_f32 v90, v56, v57
    v_mul_f32 v60, v60, v232
    v_mul_f32 v61, v61, v232
    v_cvt_pk_bf16_f32 v91, v58, v59
    v_mul_f32 v62, v62, v232
    v_mul_f32 v63, v63, v232
    v_cvt_pk_bf16_f32 v94, v60, v61
    v_cvt_pk_bf16_f32 v95, v62, v63
    v_permlane16_swap_b32 v88, v90
    v_permlane16_swap_b32 v89, v91
    ds_bpermute_b32 v88, v225, v88
    ds_bpermute_b32 v89, v225, v89
    ds_bpermute_b32 v90, v225, v90
    ds_bpermute_b32 v91, v225, v91
    s_waitcnt lgkmcnt(0)
    buffer_store_dwordx4 v[88:91], v223, s[28:31], 0 offen offset:192
    v_permlane16_swap_b32 v92, v94
    v_permlane16_swap_b32 v93, v95
    ds_bpermute_b32 v92, v225, v92
    ds_bpermute_b32 v93, v225, v93
    ds_bpermute_b32 v94, v225, v94
    ds_bpermute_b32 v95, v225, v95
    s_waitcnt lgkmcnt(0)
    buffer_store_dwordx4 v[92:95], v223, s[28:31], 0 offen offset:448
    s_waitcnt vmcnt(0) lgkmcnt(0)
    s_nop 7
    s_nop 7
L_sk1:
L_end:
    s_endpgm
.section .rodata,"a"
.p2align 6
.amdhsa_kernel standalone__mha_softmax__near_ridge_kernel
  .amdhsa_next_free_vgpr 256
  .amdhsa_next_free_sgpr 102
  .amdhsa_accum_offset 256
  .amdhsa_group_segment_fixed_size 0
  .amdhsa_kernarg_size 48
  .amdhsa_user_sgpr_count 2
  .amdhsa_user_sgpr_kernarg_segment_ptr 1
  .amdhsa_system_sgpr_workgroup_id_x 1
.end_amdhsa_kernel
```
